```python
import torch

def _softmax(x, axis=-1):
    return torch.softmax(x, dim=axis)

def _gelu(x):
    return torch.nn.functional.gelu(x, approximate='tanh')

def _silu(x):
    return torch.nn.functional.silu(x)

def _sigmoid(x):
    return torch.sigmoid(x)

def _layernorm(x, axis=-1, eps=1e-05):
    m = x.mean(dim=axis, keepdim=True)
    v = x.var(dim=axis, keepdim=True, unbiased=False)
    return (x - m) / torch.sqrt(v + eps)

def _scatter_add(tgt, idx, src, axis=0):
    return tgt.clone().index_add_(axis, idx, src)

def _segment_sum(src, seg, n):
    out = torch.zeros((n,) + src.shape[1:], dtype=src.dtype)
    return out.index_add_(0, seg, src)

def _pad(x, pw):
    flat = tuple((v for pair in reversed(pw) for v in pair))
    return torch.nn.functional.pad(x, flat)
kernel_name = 'standalone__kv_cache_quant_pre_rope_vs_post_rope__prompt'

def setup_inputs():

    _w = lambda a: (lambda t: t.to(torch.bfloat16) if t.is_floating_point() else t)(torch.as_tensor(a))
    B, Sq, Skv = (1, 2048, 2048)
    H, Dh0 = (4, 128)
    G = 32 if 32 > 0 else Dh0
    G = max(2, G // 2 * 2)
    Dh = max(G, Dh0 // G * G)
    Skv = max(Skv, Sq)
    ng = Dh // G
    bits = 8 if 8 > 1 else 4
    bits = max(2, min(8, bits))
    qmax = (1 << bits) - 1
    half = Dh // 2
    inv = 1.0 / 10000.0 ** (torch.arange(half) / max(1, half))
    ang_k = torch.arange(Skv)[:, None] * inv[None, :]
    ang_q = torch.arange(Skv - Sq, Skv)[:, None] * inv[None, :]
    kc = torch.cat([torch.cos(ang_k), torch.cos(ang_k)], dim=-1)
    ks = torch.cat([torch.sin(ang_k), torch.sin(ang_k)], dim=-1)
    qc = torch.cat([torch.cos(ang_q), torch.cos(ang_q)], dim=-1)
    qs = torch.cat([torch.sin(ang_q), torch.sin(ang_q)], dim=-1)
    qk_i = torch.randint(0, qmax + 1, (B, H, Skv, Dh)).to(torch.int32)
    qv_i = torch.randint(0, qmax + 1, (B, H, Skv, Dh)).to(torch.int32)
    ksc = torch.abs((lambda *s: torch.randn(*s, dtype=torch.bfloat16) * 0.05)(B, H, Skv, ng)) * 0.1 + 0.01
    kzp = torch.full((B, H, Skv, ng), qmax / 2.0)
    vsc = torch.abs((lambda *s: torch.randn(*s, dtype=torch.bfloat16) * 0.05)(B, H, Skv, ng)) * 0.1 + 0.01
    vzp = torch.full((B, H, Skv, ng), qmax / 2.0)
    return {'q': _w((lambda *s: torch.randn(*s, dtype=torch.bfloat16) * 0.8)(B, H, Sq, Dh) * 0.5), 'qk': _w(qk_i), 'k_scales': _w(ksc), 'k_zeros': _w(kzp), 'qv': _w(qv_i), 'v_scales': _w(vsc), 'v_zeros': _w(vzp), 'q_cos': _w(qc), 'q_sin': _w(qs), 'k_cos': _w(kc), 'k_sin': _w(ks)}

def reference(q, qk, k_scales, k_zeros, qv, v_scales, v_zeros, q_cos, q_sin, k_cos, k_sin):
    B, H, Sq, Dh = q.shape
    ng = k_scales.shape[-1]
    G = Dh // ng
    half = Dh // 2
    ks = (lambda x, n, axis: torch.repeat_interleave(x, n, dim=axis))(k_scales, G, axis=-1)
    kz = (lambda x, n, axis: torch.repeat_interleave(x, n, dim=axis))(k_zeros, G, axis=-1)
    k = ((lambda x, dt: x.to(dt))(qk, q.dtype) - kz) * ks
    vs = (lambda x, n, axis: torch.repeat_interleave(x, n, dim=axis))(v_scales, G, axis=-1)
    vz = (lambda x, n, axis: torch.repeat_interleave(x, n, dim=axis))(v_zeros, G, axis=-1)
    v = ((lambda x, dt: x.to(dt))(qv, q.dtype) - vz) * vs
    k1 = k[..., :half].clone()
    k2 = k[..., half:].clone()
    krh = torch.concatenate([-k2, k1], axis=-1)
    kr = k * k_cos[None, None, :, :] + krh * k_sin[None, None, :, :]
    q1 = q[..., :half].clone()
    q2 = q[..., half:].clone()
    qrh = torch.concatenate([-q2, q1], axis=-1)
    qr = q * q_cos[None, None, :, :] + qrh * q_sin[None, None, :, :]
    logits = torch.einsum('bhqd,bhkd->bhqk', qr, kr) * float(Dh) ** (-0.5)
    attn = _softmax(logits, axis=-1)
    out = torch.einsum('bhqk,bhkd->bhqd', attn, v)
    return out
```

```asm
; @launch grid=(256,1,1) block=(256,1,1) lds=116800
.amdgcn_target "amdgcn-amd-amdhsa--gfx950"
.text
.globl standalone__kv_cache_quant_pre_rope_vs_post_rope__prompt_kernel
.p2align 8
.type standalone__kv_cache_quant_pre_rope_vs_post_rope__prompt_kernel,@function
standalone__kv_cache_quant_pre_rope_vs_post_rope__prompt_kernel:
s_cmp_ge_u32 s2, 256
s_cbranch_scc1 L_END
s_load_dwordx16 s[20:35], s[0:1], 0
s_load_dwordx4 s[36:39], s[0:1], 96
s_load_dwordx2 s[40:41], s[0:1], 88
s_memrealtime s[92:93]
v_lshrrev_b32 v8, 6, v0
v_and_b32 v0, 63, v0
v_readfirstlane_b32 s3, v8
v_lshlrev_b32 v1, 4, v0
s_and_b32 s8, s2, 7
s_lshr_b32 s4, s8, 1
s_and_b32 s5, s8, 1
s_lshr_b32 s6, s2, 3
s_lshl_b32 s8, s4, 6
s_lshl_b32 s9, s5, 5
s_add_u32 s8, s8, s9
s_add_u32 s7, s8, s6
s_mov_b32 s97, s6
s_lshl_b32 s96, s5, 5
s_add_u32 s96, s96, s6
v_and_b32 v8, 15, v0
v_lshrrev_b32 v9, 4, v0
s_lshl_b32 s9, s3, 2
v_add_u32 v9, s9, v9
v_lshlrev_b32 v10, 9, v9
v_lshl_add_u32 v10, v8, 4, v10
v_add_u32 v11, 8192, v10
v_lshlrev_b32 v12, 3, v9
v_and_b32 v132, 31, v0
v_lshrrev_b32 v133, 5, v0
v_bfe_u32 v134, v132, 2, 1
v_lshlrev_b32 v134, 4, v134
v_lshrrev_b32 v135, 3, v132
v_lshl_add_u32 v134, v135, 2, v134
v_and_b32 v135, 3, v132
v_add_u32 v134, v134, v135
s_and_b32 s10, s3, 1
s_lshr_b32 s11, s3, 1
s_lshl_b32 s9, s10, 4
v_lshlrev_b32 v133, 2, v133
v_add_u32 v133, s9, v133
s_lshl_b32 s9, s11, 8
s_add_u32 s9, s9, 2048
v_lshlrev_b32 v13, 9, v133
v_lshl_add_u32 v13, v134, 2, v13
v_add_u32 v13, s9, v13
s_lshl_b32 s9, s11, 2
v_lshlrev_b32 v14, 3, v133
v_add_u32 v14, s9, v14
s_lshl_b32 s42, s7, 14
s_lshl_b32 s43, s7, 8
s_lshl_b32 s9, s8, 3
s_add_u32 s65, s9, 7340032
s_mov_b32 s98, s65
v_mov_b32 v135, s65
v_lshlrev_b32 v132, 2, v8
v_cvt_f32_u32 v132, v132
s_mov_b32 s9, 0xbe549a78
v_mov_b32 v20, 0xc029b21d
v_mov_b32 v21, 0xc036fbc4
v_mov_b32 v22, 0xc044456c
v_mov_b32 v23, 0xc0518f13
v_fma_f32 v20, v132, s9, v20
v_fma_f32 v21, v132, s9, v21
v_fma_f32 v22, v132, s9, v22
v_fma_f32 v23, v132, s9, v23
v_exp_f32 v20, v20
v_exp_f32 v21, v21
v_exp_f32 v22, v22
v_exp_f32 v23, v23
s_lshl_b32 s9, s96, 5
v_add_u32 v136, s9, v9
v_cvt_f32_u32 v136, v136
v_mul_f32 v137, v136, v20
v_mul_f32 v138, v136, v21
v_mul_f32 v139, v136, v22
v_mul_f32 v140, v136, v23
v_fract_f32 v137, v137
v_fract_f32 v138, v138
v_fract_f32 v139, v139
v_fract_f32 v140, v140
v_cos_f32 v24, v137
v_sin_f32 v32, v137
v_cos_f32 v25, v138
v_sin_f32 v33, v138
v_cos_f32 v26, v139
v_sin_f32 v34, v139
v_cos_f32 v27, v140
v_sin_f32 v35, v140
s_waitcnt lgkmcnt(0)
s_or_b32 s10, s2, s3
s_cmp_lg_u32 s10, 0
s_cbranch_scc1 L_NONONCE
s_or_b32 s10, s92, 1
v_mov_b32 v133, 0
v_mov_b32 v134, s10
s_mov_b64 exec, 1
global_store_dword v133, v134, s[36:37] sc1
s_mov_b64 exec, -1
L_NONONCE:
s_add_u32 s22, s22, s42
s_addc_u32 s23, s23, 0
s_add_u32 s24, s24, s43
s_addc_u32 s25, s25, 0
s_add_u32 s26, s26, s43
s_addc_u32 s27, s27, 0
global_load_dwordx4 v[72:75], v10, s[22:23]
global_load_dwordx4 v[76:79], v10, s[22:23] offset:256
global_load_dwordx2 v[88:89], v12, s[24:25] offset:0
global_load_dwordx2 v[92:93], v12, s[26:27] offset:0
global_load_dwordx4 v[80:83], v11, s[22:23]
global_load_dwordx4 v[84:87], v11, s[22:23] offset:256
global_load_dwordx2 v[90:91], v12, s[24:25] offset:128
global_load_dwordx2 v[94:95], v12, s[26:27] offset:128
s_add_u32 s28, s28, s42
s_addc_u32 s29, s29, 0
s_add_u32 s30, s30, s43
s_addc_u32 s31, s31, 0
s_add_u32 s32, s32, s43
s_addc_u32 s33, s33, 0
global_load_dword v112, v14, s[30:31] offset:0
global_load_dword v120, v14, s[32:33] offset:0
global_load_dword v113, v14, s[30:31] offset:8
global_load_dword v121, v14, s[32:33] offset:8
global_load_dword v114, v14, s[30:31] offset:16
global_load_dword v122, v14, s[32:33] offset:16
global_load_dword v115, v14, s[30:31] offset:24
global_load_dword v123, v14, s[32:33] offset:24
global_load_dword v116, v14, s[30:31] offset:64
global_load_dword v124, v14, s[32:33] offset:64
global_load_dword v117, v14, s[30:31] offset:72
global_load_dword v125, v14, s[32:33] offset:72
global_load_dword v118, v14, s[30:31] offset:80
global_load_dword v126, v14, s[32:33] offset:80
global_load_dword v119, v14, s[30:31] offset:88
global_load_dword v127, v14, s[32:33] offset:88
global_load_dword v96, v13, s[28:29] offset:-2048
global_load_dword v97, v13, s[28:29] offset:-1920
global_load_dword v98, v13, s[28:29] offset:-1536
global_load_dword v99, v13, s[28:29] offset:-1408
global_load_dword v100, v13, s[28:29] offset:-1024
global_load_dword v101, v13, s[28:29] offset:-896
global_load_dword v102, v13, s[28:29] offset:-512
global_load_dword v103, v13, s[28:29] offset:-384
global_load_dword v104, v13, s[28:29] offset:2048
global_load_dword v105, v13, s[28:29] offset:2176
global_load_dword v106, v13, s[28:29] offset:2560
global_load_dword v107, v13, s[28:29] offset:2688
global_load_dword v108, v13, s[28:29] offset:3072
global_load_dword v109, v13, s[28:29] offset:3200
global_load_dword v110, v13, s[28:29] offset:3584
global_load_dword v111, v13, s[28:29] offset:3712
global_load_dword v171, v135, s[38:39] sc1
s_mov_b32 s12, s38
s_and_b32 s13, s39, 0xffff
s_mov_b32 s14, 8388608
s_mov_b32 s15, 0x20000
v_lshlrev_b32 v19, 2, v0
s_lshl_b32 s44, s2, 13
s_lshl_b32 s10, s3, 11
s_add_u32 s44, s44, s10
s_add_u32 s44, s44, 4194304
s_lshl_b32 s45, s2, 10
s_lshl_b32 s10, s3, 8
s_add_u32 s45, s45, s10
s_add_u32 s45, s45, 6291456
v_add_u32 v136, s9, v9
v_add_u32 v136, 16, v136
v_cvt_f32_u32 v136, v136
v_mul_f32 v137, v136, v20
v_mul_f32 v138, v136, v21
v_mul_f32 v139, v136, v22
v_mul_f32 v140, v136, v23
v_fract_f32 v137, v137
v_fract_f32 v138, v138
v_fract_f32 v139, v139
v_fract_f32 v140, v140
v_cos_f32 v28, v137
v_sin_f32 v36, v137
v_cos_f32 v29, v138
v_sin_f32 v37, v138
v_cos_f32 v30, v139
v_sin_f32 v38, v139
v_cos_f32 v31, v140
v_sin_f32 v39, v140
v_lshrrev_b32 v132, 1, v8
v_lshlrev_b32 v16, 10, v132
v_and_b32 v133, 1, v8
v_lshl_add_u32 v16, v133, 9, v16
v_lshl_add_u32 v16, v9, 4, v16
v_lshl_add_u32 v133, v133, 5, v9
v_and_b32 v134, 7, v8
v_xor_b32 v133, v133, v134
v_lshlrev_b32 v17, 10, v132
v_lshl_add_u32 v17, v133, 4, v17
v_lshrrev_b32 v18, 3, v8
v_lshlrev_b32 v18, 4, v18
v_sub_u32 v18, 16, v18
s_lshl_b32 s43, s7, 14
s_and_b32 s9, s3, 1
s_lshl_b32 s9, s9, 10
s_lshr_b32 s10, s3, 1
s_lshl_b32 s10, s10, 12
s_add_u32 s9, s9, s10
s_add_u32 s9, s9, s43
s_add_u32 s9, s9, 8192
s_waitcnt vmcnt(37)
v_lshlrev_b32 v148, v18, v88
v_lshlrev_b32 v149, v18, v89
v_lshlrev_b32 v150, v18, v92
v_lshlrev_b32 v151, v18, v93
v_cvt_f32_i32 v72, v72
v_cvt_f32_i32 v73, v73
v_cvt_f32_i32 v74, v74
v_cvt_f32_i32 v75, v75
v_cvt_f32_i32 v76, v76
v_cvt_f32_i32 v77, v77
v_cvt_f32_i32 v78, v78
v_cvt_f32_i32 v79, v79
v_and_b32 v148, 0xffff0000, v148
v_and_b32 v149, 0xffff0000, v149
v_and_b32 v150, 0xffff0000, v150
v_and_b32 v151, 0xffff0000, v151
v_pk_add_f32 v[72:73], v[72:73], v[150:151] op_sel_hi:[1,0] neg_lo:[0,1] neg_hi:[0,1]
v_pk_add_f32 v[76:77], v[76:77], v[150:151] op_sel:[0,1] op_sel_hi:[1,1] neg_lo:[0,1] neg_hi:[0,1]
v_pk_add_f32 v[74:75], v[74:75], v[150:151] op_sel_hi:[1,0] neg_lo:[0,1] neg_hi:[0,1]
v_pk_add_f32 v[78:79], v[78:79], v[150:151] op_sel:[0,1] op_sel_hi:[1,1] neg_lo:[0,1] neg_hi:[0,1]
v_pk_mul_f32 v[72:73], v[72:73], v[148:149] op_sel_hi:[1,0]
v_pk_mul_f32 v[76:77], v[76:77], v[148:149] op_sel:[0,1] op_sel_hi:[1,1]
v_pk_mul_f32 v[74:75], v[74:75], v[148:149] op_sel_hi:[1,0]
v_pk_mul_f32 v[78:79], v[78:79], v[148:149] op_sel:[0,1] op_sel_hi:[1,1]
v_pk_mul_f32 v[140:141], v[76:77], v[32:33]
v_pk_mul_f32 v[144:145], v[72:73], v[32:33]
v_pk_mul_f32 v[142:143], v[78:79], v[34:35]
v_pk_mul_f32 v[146:147], v[74:75], v[34:35]
v_pk_fma_f32 v[140:141], v[72:73], v[24:25], v[140:141] neg_lo:[0,0,1] neg_hi:[0,0,1]
v_pk_fma_f32 v[144:145], v[76:77], v[24:25], v[144:145]
v_pk_fma_f32 v[142:143], v[74:75], v[26:27], v[142:143] neg_lo:[0,0,1] neg_hi:[0,0,1]
v_pk_fma_f32 v[146:147], v[78:79], v[26:27], v[146:147]
v_cvt_pk_bf16_f32 v152, v140, v141
v_cvt_pk_bf16_f32 v153, v142, v143
v_cvt_pk_bf16_f32 v154, v144, v145
v_cvt_pk_bf16_f32 v155, v146, v147
buffer_store_dwordx4 v[152:155], v16, s[12:15], s43 offen offset:0 sc1
s_waitcnt vmcnt(34)
v_lshlrev_b32 v148, v18, v90
v_lshlrev_b32 v149, v18, v91
v_lshlrev_b32 v150, v18, v94
v_lshlrev_b32 v151, v18, v95
v_cvt_f32_i32 v80, v80
v_cvt_f32_i32 v81, v81
v_cvt_f32_i32 v82, v82
v_cvt_f32_i32 v83, v83
v_cvt_f32_i32 v84, v84
v_cvt_f32_i32 v85, v85
v_cvt_f32_i32 v86, v86
v_cvt_f32_i32 v87, v87
v_and_b32 v148, 0xffff0000, v148
v_and_b32 v149, 0xffff0000, v149
v_and_b32 v150, 0xffff0000, v150
v_and_b32 v151, 0xffff0000, v151
v_pk_add_f32 v[80:81], v[80:81], v[150:151] op_sel_hi:[1,0] neg_lo:[0,1] neg_hi:[0,1]
v_pk_add_f32 v[84:85], v[84:85], v[150:151] op_sel:[0,1] op_sel_hi:[1,1] neg_lo:[0,1] neg_hi:[0,1]
v_pk_add_f32 v[82:83], v[82:83], v[150:151] op_sel_hi:[1,0] neg_lo:[0,1] neg_hi:[0,1]
v_pk_add_f32 v[86:87], v[86:87], v[150:151] op_sel:[0,1] op_sel_hi:[1,1] neg_lo:[0,1] neg_hi:[0,1]
v_pk_mul_f32 v[80:81], v[80:81], v[148:149] op_sel_hi:[1,0]
v_pk_mul_f32 v[84:85], v[84:85], v[148:149] op_sel:[0,1] op_sel_hi:[1,1]
v_pk_mul_f32 v[82:83], v[82:83], v[148:149] op_sel_hi:[1,0]
v_pk_mul_f32 v[86:87], v[86:87], v[148:149] op_sel:[0,1] op_sel_hi:[1,1]
v_pk_mul_f32 v[140:141], v[84:85], v[36:37]
v_pk_mul_f32 v[144:145], v[80:81], v[36:37]
v_pk_mul_f32 v[142:143], v[86:87], v[38:39]
v_pk_mul_f32 v[146:147], v[82:83], v[38:39]
v_pk_fma_f32 v[140:141], v[80:81], v[28:29], v[140:141] neg_lo:[0,0,1] neg_hi:[0,0,1]
v_pk_fma_f32 v[144:145], v[84:85], v[28:29], v[144:145]
v_pk_fma_f32 v[142:143], v[82:83], v[30:31], v[142:143] neg_lo:[0,0,1] neg_hi:[0,0,1]
v_pk_fma_f32 v[146:147], v[86:87], v[30:31], v[146:147]
v_cvt_pk_bf16_f32 v156, v140, v141
v_cvt_pk_bf16_f32 v157, v142, v143
v_cvt_pk_bf16_f32 v158, v144, v145
v_cvt_pk_bf16_f32 v159, v146, v147
buffer_store_dwordx4 v[156:159], v16, s[12:15], s43 offen offset:256 sc1
s_waitcnt vmcnt(19)
v_lshlrev_b32 v72, 16, v112
v_and_b32 v73, 0xffff0000, v112
v_lshlrev_b32 v24, 16, v120
v_and_b32 v25, 0xffff0000, v120
v_lshlrev_b32 v74, 16, v113
v_and_b32 v75, 0xffff0000, v113
v_lshlrev_b32 v26, 16, v121
v_and_b32 v27, 0xffff0000, v121
v_lshlrev_b32 v76, 16, v114
v_and_b32 v77, 0xffff0000, v114
v_lshlrev_b32 v28, 16, v122
v_and_b32 v29, 0xffff0000, v122
v_lshlrev_b32 v78, 16, v115
v_and_b32 v79, 0xffff0000, v115
v_lshlrev_b32 v30, 16, v123
v_and_b32 v31, 0xffff0000, v123
v_lshlrev_b32 v80, 16, v116
v_and_b32 v81, 0xffff0000, v116
v_lshlrev_b32 v32, 16, v124
v_and_b32 v33, 0xffff0000, v124
v_lshlrev_b32 v82, 16, v117
v_and_b32 v83, 0xffff0000, v117
v_lshlrev_b32 v34, 16, v125
v_and_b32 v35, 0xffff0000, v125
v_lshlrev_b32 v84, 16, v118
v_and_b32 v85, 0xffff0000, v118
v_lshlrev_b32 v36, 16, v126
v_and_b32 v37, 0xffff0000, v126
v_lshlrev_b32 v86, 16, v119
v_and_b32 v87, 0xffff0000, v119
v_lshlrev_b32 v38, 16, v127
v_and_b32 v39, 0xffff0000, v127
s_waitcnt vmcnt(3)
v_mov_b32 v133, 0
global_load_dword v129, v133, s[36:37] sc1
v_cvt_f32_i32 v96, v96
v_cvt_f32_i32 v97, v97
v_cvt_f32_i32 v98, v98
v_cvt_f32_i32 v99, v99
v_cvt_f32_i32 v100, v100
v_cvt_f32_i32 v101, v101
v_cvt_f32_i32 v102, v102
v_cvt_f32_i32 v103, v103
v_cvt_f32_i32 v104, v104
v_cvt_f32_i32 v105, v105
v_cvt_f32_i32 v106, v106
v_cvt_f32_i32 v107, v107
v_cvt_f32_i32 v108, v108
v_cvt_f32_i32 v109, v109
v_cvt_f32_i32 v110, v110
v_cvt_f32_i32 v111, v111
v_pk_add_f32 v[96:97], v[96:97], v[24:25] neg_lo:[0,1] neg_hi:[0,1]
v_pk_add_f32 v[98:99], v[98:99], v[26:27] neg_lo:[0,1] neg_hi:[0,1]
v_pk_add_f32 v[100:101], v[100:101], v[28:29] neg_lo:[0,1] neg_hi:[0,1]
v_pk_add_f32 v[102:103], v[102:103], v[30:31] neg_lo:[0,1] neg_hi:[0,1]
v_pk_add_f32 v[104:105], v[104:105], v[32:33] neg_lo:[0,1] neg_hi:[0,1]
v_pk_add_f32 v[106:107], v[106:107], v[34:35] neg_lo:[0,1] neg_hi:[0,1]
v_pk_add_f32 v[108:109], v[108:109], v[36:37] neg_lo:[0,1] neg_hi:[0,1]
v_pk_add_f32 v[110:111], v[110:111], v[38:39] neg_lo:[0,1] neg_hi:[0,1]
v_pk_mul_f32 v[96:97], v[96:97], v[72:73]
v_pk_mul_f32 v[98:99], v[98:99], v[74:75]
v_pk_mul_f32 v[100:101], v[100:101], v[76:77]
v_pk_mul_f32 v[102:103], v[102:103], v[78:79]
v_pk_mul_f32 v[104:105], v[104:105], v[80:81]
v_pk_mul_f32 v[106:107], v[106:107], v[82:83]
v_pk_mul_f32 v[108:109], v[108:109], v[84:85]
v_pk_mul_f32 v[110:111], v[110:111], v[86:87]
v_cvt_pk_bf16_f32 v160, v96, v98
v_cvt_pk_bf16_f32 v161, v100, v102
v_cvt_pk_bf16_f32 v162, v104, v106
v_cvt_pk_bf16_f32 v163, v108, v110
buffer_store_dwordx4 v[160:163], v1, s[12:15], s9 offen offset:0 sc1
v_cvt_pk_bf16_f32 v164, v97, v99
v_cvt_pk_bf16_f32 v165, v101, v103
v_cvt_pk_bf16_f32 v166, v105, v107
v_cvt_pk_bf16_f32 v167, v109, v111
buffer_store_dwordx4 v[164:167], v1, s[12:15], s9 offen offset:2048 sc1
v_lshlrev_b32 v15, 8, v9
v_lshl_add_u32 v15, v8, 3, v15
v_add_u32 v15, 2048, v15
s_lshl_b32 s9, s6, 1
s_add_u32 s46, s9, s5
s_xor_b32 s47, s46, 1
s_lshl_b32 s10, s4, 6
s_add_u32 s11, s10, s47
s_lshl_b32 s11, s11, 13
s_add_u32 s34, s20, s11
s_addc_u32 s35, s21, 0
s_add_u32 s11, s10, s46
s_lshl_b32 s11, s11, 13
s_add_u32 s20, s20, s11
s_addc_u32 s21, s21, 0
global_load_dwordx2 v[72:73], v15, s[34:35] offset:-2048
global_load_dwordx2 v[74:75], v15, s[34:35] offset:-1920
global_load_dwordx2 v[76:77], v15, s[34:35] offset:2048
global_load_dwordx2 v[78:79], v15, s[34:35] offset:2176
global_load_dwordx2 v[80:81], v15, s[20:21] offset:-2048
global_load_dwordx2 v[82:83], v15, s[20:21] offset:-1920
global_load_dwordx2 v[84:85], v15, s[20:21] offset:2048
global_load_dwordx2 v[86:87], v15, s[20:21] offset:2176
s_lshl_b32 s10, s47, 5
s_lshl_b32 s11, s46, 5
s_mov_b32 s42, 0x3e0293ee
s_mov_b32 s43, 0x3e0293ee
v_add_u32 v136, s10, v9
v_cvt_f32_u32 v136, v136
v_mul_f32 v137, v136, v20
v_mul_f32 v138, v136, v21
v_mul_f32 v139, v136, v22
v_mul_f32 v140, v136, v23
v_fract_f32 v137, v137
v_fract_f32 v138, v138
v_fract_f32 v139, v139
v_fract_f32 v140, v140
v_cos_f32 v40, v137
v_sin_f32 v56, v137
v_cos_f32 v41, v138
v_sin_f32 v57, v138
v_cos_f32 v42, v139
v_sin_f32 v58, v139
v_cos_f32 v43, v140
v_sin_f32 v59, v140
s_nop 0
v_pk_mul_f32 v[40:41], v[40:41], s[42:43]
v_pk_mul_f32 v[56:57], v[56:57], s[42:43]
v_pk_mul_f32 v[42:43], v[42:43], s[42:43]
v_pk_mul_f32 v[58:59], v[58:59], s[42:43]
v_add_u32 v136, s10, v9
v_add_u32 v136, 16, v136
v_cvt_f32_u32 v136, v136
v_mul_f32 v137, v136, v20
v_mul_f32 v138, v136, v21
v_mul_f32 v139, v136, v22
v_mul_f32 v140, v136, v23
v_fract_f32 v137, v137
v_fract_f32 v138, v138
v_fract_f32 v139, v139
v_fract_f32 v140, v140
v_cos_f32 v44, v137
v_sin_f32 v60, v137
v_cos_f32 v45, v138
v_sin_f32 v61, v138
v_cos_f32 v46, v139
v_sin_f32 v62, v139
v_cos_f32 v47, v140
v_sin_f32 v63, v140
s_nop 0
v_pk_mul_f32 v[44:45], v[44:45], s[42:43]
v_pk_mul_f32 v[60:61], v[60:61], s[42:43]
v_pk_mul_f32 v[46:47], v[46:47], s[42:43]
v_pk_mul_f32 v[62:63], v[62:63], s[42:43]
s_add_u32 s9, s3, 0
s_and_b32 s9, s9, 3
s_lshl_b32 s9, s9, 11
s_add_u32 s9, s9, 8192
v_add_u32 v2, s9, v1
s_add_u32 s9, s3, 1
s_and_b32 s9, s9, 3
s_lshl_b32 s9, s9, 11
s_add_u32 s9, s9, 8192
v_add_u32 v3, s9, v1
s_add_u32 s9, s3, 2
s_and_b32 s9, s9, 3
s_lshl_b32 s9, s9, 11
s_add_u32 s9, s9, 8192
v_add_u32 v4, s9, v1
s_add_u32 s9, s3, 3
s_and_b32 s9, s9, 3
s_lshl_b32 s9, s9, 11
s_add_u32 s9, s9, 8192
v_add_u32 v5, s9, v1
s_lshl_b32 s9, s3, 3
s_add_u32 s8, s8, s9
s_lshl_b32 s48, s8, 14
s_add_u32 s49, s48, 4096
s_add_u32 s50, s48, 16384
s_add_u32 s51, s48, 20480
s_add_u32 s52, s48, 32768
s_add_u32 s53, s48, 36864
s_add_u32 s54, s48, 49152
s_add_u32 s55, s48, 53248
s_add_u32 s56, s48, 65536
s_add_u32 s57, s48, 69632
s_add_u32 s58, s48, 81920
s_add_u32 s59, s48, 86016
s_add_u32 s60, s48, 98304
s_add_u32 s61, s48, 102400
s_add_u32 s62, s48, 114688
s_add_u32 s63, s48, 118784
s_lshl_b32 s9, s97, 2
s_add_u32 s9, s9, s65
v_mov_b32 v132, s9
s_lshl_b32 s9, s3, 5
s_add_u32 s9, s9, s98
v_and_b32 v134, 7, v0
v_lshl_add_u32 v134, v134, 2, s9
s_mov_b32 s10, 0
s_mov_b32 s9, 0
s_waitcnt vmcnt(8)
L_NPOLL:
v_readfirstlane_b32 s64, v129
s_nop 1
s_sub_u32 s94, s64, s92
s_add_u32 s94, s94, 500
s_cmp_lt_u32 s94, 2500
s_cselect_b32 s94, s64, 0
s_cmp_lg_u32 s94, 0
s_cbranch_scc1 L_NOK
s_add_u32 s10, s10, 1
s_cmp_ge_u32 s10, 200
s_cbranch_scc1 L_NTIMEOUT
v_mov_b32 v133, 0
global_load_dword v129, v133, s[36:37] sc1
s_waitcnt vmcnt(0)
s_branch L_NPOLL
L_NTIMEOUT:
s_mov_b32 s64, 1
s_mov_b32 s9, 1
L_NOK:
v_mov_b32 v133, s64
s_barrier
s_mov_b64 exec, 1
global_store_dword v132, v133, s[38:39]
s_mov_b64 exec, 0xff
global_load_dword v130, v134, s[38:39] sc1
s_mov_b64 exec, -1
s_mov_b32 s65, s9
v_add_u32 v136, s11, v9
v_cvt_f32_u32 v136, v136
v_mul_f32 v137, v136, v20
v_mul_f32 v138, v136, v21
v_mul_f32 v139, v136, v22
v_mul_f32 v140, v136, v23
v_fract_f32 v137, v137
v_fract_f32 v138, v138
v_fract_f32 v139, v139
v_fract_f32 v140, v140
v_cos_f32 v48, v137
v_sin_f32 v64, v137
v_cos_f32 v49, v138
v_sin_f32 v65, v138
v_cos_f32 v50, v139
v_sin_f32 v66, v139
v_cos_f32 v51, v140
v_sin_f32 v67, v140
s_nop 0
v_pk_mul_f32 v[48:49], v[48:49], s[42:43]
v_pk_mul_f32 v[64:65], v[64:65], s[42:43]
v_pk_mul_f32 v[50:51], v[50:51], s[42:43]
v_pk_mul_f32 v[66:67], v[66:67], s[42:43]
v_add_u32 v136, s11, v9
v_add_u32 v136, 16, v136
v_cvt_f32_u32 v136, v136
v_mul_f32 v137, v136, v20
v_mul_f32 v138, v136, v21
v_mul_f32 v139, v136, v22
v_mul_f32 v140, v136, v23
v_fract_f32 v137, v137
v_fract_f32 v138, v138
v_fract_f32 v139, v139
v_fract_f32 v140, v140
v_cos_f32 v52, v137
v_sin_f32 v68, v137
v_cos_f32 v53, v138
v_sin_f32 v69, v138
v_cos_f32 v54, v139
v_sin_f32 v70, v139
v_cos_f32 v55, v140
v_sin_f32 v71, v140
s_nop 0
v_pk_mul_f32 v[52:53], v[52:53], s[42:43]
v_pk_mul_f32 v[68:69], v[68:69], s[42:43]
v_pk_mul_f32 v[54:55], v[54:55], s[42:43]
v_pk_mul_f32 v[70:71], v[70:71], s[42:43]
s_waitcnt vmcnt(2)
v_lshlrev_b32 v96, 16, v72
v_and_b32 v97, 0xffff0000, v72
v_lshlrev_b32 v98, 16, v73
v_and_b32 v99, 0xffff0000, v73
v_lshlrev_b32 v100, 16, v74
v_and_b32 v101, 0xffff0000, v74
v_lshlrev_b32 v102, 16, v75
v_and_b32 v103, 0xffff0000, v75
v_pk_mul_f32 v[140:141], v[100:101], v[56:57]
v_pk_mul_f32 v[144:145], v[96:97], v[56:57]
v_pk_mul_f32 v[142:143], v[102:103], v[58:59]
v_pk_mul_f32 v[146:147], v[98:99], v[58:59]
v_pk_fma_f32 v[140:141], v[96:97], v[40:41], v[140:141] neg_lo:[0,0,1] neg_hi:[0,0,1]
v_pk_fma_f32 v[144:145], v[100:101], v[40:41], v[144:145]
v_pk_fma_f32 v[142:143], v[98:99], v[42:43], v[142:143] neg_lo:[0,0,1] neg_hi:[0,0,1]
v_pk_fma_f32 v[146:147], v[102:103], v[42:43], v[146:147]
v_cvt_pk_bf16_f32 v152, v140, v141
v_cvt_pk_bf16_f32 v153, v142, v143
v_cvt_pk_bf16_f32 v154, v144, v145
v_cvt_pk_bf16_f32 v155, v146, v147
ds_write_b128 v17, v[152:155] offset:0
v_lshlrev_b32 v104, 16, v76
v_and_b32 v105, 0xffff0000, v76
v_lshlrev_b32 v106, 16, v77
v_and_b32 v107, 0xffff0000, v77
v_lshlrev_b32 v108, 16, v78
v_and_b32 v109, 0xffff0000, v78
v_lshlrev_b32 v110, 16, v79
v_and_b32 v111, 0xffff0000, v79
v_pk_mul_f32 v[140:141], v[108:109], v[60:61]
v_pk_mul_f32 v[144:145], v[104:105], v[60:61]
v_pk_mul_f32 v[142:143], v[110:111], v[62:63]
v_pk_mul_f32 v[146:147], v[106:107], v[62:63]
v_pk_fma_f32 v[140:141], v[104:105], v[44:45], v[140:141] neg_lo:[0,0,1] neg_hi:[0,0,1]
v_pk_fma_f32 v[144:145], v[108:109], v[44:45], v[144:145]
v_pk_fma_f32 v[142:143], v[106:107], v[46:47], v[142:143] neg_lo:[0,0,1] neg_hi:[0,0,1]
v_pk_fma_f32 v[146:147], v[110:111], v[46:47], v[146:147]
v_cvt_pk_bf16_f32 v156, v140, v141
v_cvt_pk_bf16_f32 v157, v142, v143
v_cvt_pk_bf16_f32 v158, v144, v145
v_cvt_pk_bf16_f32 v159, v146, v147
ds_write_b128 v17, v[156:159] offset:256
v_lshlrev_b32 v96, 16, v80
v_and_b32 v97, 0xffff0000, v80
v_lshlrev_b32 v98, 16, v81
v_and_b32 v99, 0xffff0000, v81
v_lshlrev_b32 v100, 16, v82
v_and_b32 v101, 0xffff0000, v82
v_lshlrev_b32 v102, 16, v83
v_and_b32 v103, 0xffff0000, v83
v_pk_mul_f32 v[140:141], v[100:101], v[64:65]
v_pk_mul_f32 v[144:145], v[96:97], v[64:65]
v_pk_mul_f32 v[142:143], v[102:103], v[66:67]
v_pk_mul_f32 v[146:147], v[98:99], v[66:67]
v_pk_fma_f32 v[140:141], v[96:97], v[48:49], v[140:141] neg_lo:[0,0,1] neg_hi:[0,0,1]
v_pk_fma_f32 v[144:145], v[100:101], v[48:49], v[144:145]
v_pk_fma_f32 v[142:143], v[98:99], v[50:51], v[142:143] neg_lo:[0,0,1] neg_hi:[0,0,1]
v_pk_fma_f32 v[146:147], v[102:103], v[50:51], v[146:147]
v_cvt_pk_bf16_f32 v152, v140, v141
v_cvt_pk_bf16_f32 v153, v142, v143
v_cvt_pk_bf16_f32 v154, v144, v145
v_cvt_pk_bf16_f32 v155, v146, v147
ds_write_b128 v17, v[152:155] offset:8192
v_lshlrev_b32 v104, 16, v84
v_and_b32 v105, 0xffff0000, v84
v_lshlrev_b32 v106, 16, v85
v_and_b32 v107, 0xffff0000, v85
v_lshlrev_b32 v108, 16, v86
v_and_b32 v109, 0xffff0000, v86
v_lshlrev_b32 v110, 16, v87
v_and_b32 v111, 0xffff0000, v87
v_pk_mul_f32 v[140:141], v[108:109], v[68:69]
v_pk_mul_f32 v[144:145], v[104:105], v[68:69]
v_pk_mul_f32 v[142:143], v[110:111], v[70:71]
v_pk_mul_f32 v[146:147], v[106:107], v[70:71]
v_pk_fma_f32 v[140:141], v[104:105], v[52:53], v[140:141] neg_lo:[0,0,1] neg_hi:[0,0,1]
v_pk_fma_f32 v[144:145], v[108:109], v[52:53], v[144:145]
v_pk_fma_f32 v[142:143], v[106:107], v[54:55], v[142:143] neg_lo:[0,0,1] neg_hi:[0,0,1]
v_pk_fma_f32 v[146:147], v[110:111], v[54:55], v[146:147]
v_cvt_pk_bf16_f32 v156, v140, v141
v_cvt_pk_bf16_f32 v157, v142, v143
v_cvt_pk_bf16_f32 v158, v144, v145
v_cvt_pk_bf16_f32 v159, v146, v147
ds_write_b128 v17, v[156:159] offset:8448
v_lshrrev_b32 v135, 5, v0
v_add_u32 v8, 0, v135
v_xor_b32 v8, v8, v0
v_lshlrev_b32 v8, 4, v8
v_add_u32 v9, 2, v135
v_xor_b32 v9, v9, v0
v_lshlrev_b32 v9, 4, v9
v_add_u32 v10, 4, v135
v_xor_b32 v10, v10, v0
v_lshlrev_b32 v10, 4, v10
v_add_u32 v11, 6, v135
v_xor_b32 v11, v11, v0
v_lshlrev_b32 v11, 4, v11
v_mov_b32 v6, 0
v_mov_b32 v7, 0
s_waitcnt lgkmcnt(0)
s_barrier
ds_read_b128 a[96:99], v8 offset:0
ds_read_b128 a[128:131], v8 offset:8192
ds_read_b128 a[100:103], v9 offset:1024
ds_read_b128 a[132:135], v9 offset:9216
ds_read_b128 a[104:107], v10 offset:2048
ds_read_b128 a[136:139], v10 offset:10240
ds_read_b128 a[108:111], v11 offset:3072
ds_read_b128 a[140:143], v11 offset:11264
s_cmp_lg_u32 s65, 0
s_cbranch_scc1 L_WAVEFAIL
s_mov_b32 s10, 0
s_mov_b64 exec, 0xff
s_waitcnt vmcnt(0)
L_FPOLL:
v_cmp_ne_u32 vcc, s64, v130
s_nop 0
s_cbranch_vccz L_FOK
s_add_u32 s10, s10, 1
s_cmp_ge_u32 s10, 400
s_cbranch_scc1 L_WAVEFAIL
global_load_dword v130, v134, s[38:39] sc1
s_waitcnt vmcnt(0)
s_branch L_FPOLL
L_FOK:
s_mov_b64 exec, -1
buffer_load_dwordx4 a[160:163], v1, s[12:15], s48 offen offset:0
buffer_load_dwordx4 a[164:167], v1, s[12:15], s48 offen offset:1024
buffer_load_dwordx4 a[168:171], v1, s[12:15], s48 offen offset:2048
buffer_load_dwordx4 a[172:175], v1, s[12:15], s48 offen offset:3072
buffer_load_dwordx4 a[176:179], v1, s[12:15], s49 offen offset:0
buffer_load_dwordx4 a[180:183], v1, s[12:15], s49 offen offset:1024
buffer_load_dwordx4 a[184:187], v1, s[12:15], s49 offen offset:2048
buffer_load_dwordx4 a[188:191], v1, s[12:15], s49 offen offset:3072
buffer_load_dwordx4 a[192:195], v1, s[12:15], s50 offen offset:0
buffer_load_dwordx4 a[196:199], v1, s[12:15], s50 offen offset:1024
buffer_load_dwordx4 a[200:203], v1, s[12:15], s50 offen offset:2048
buffer_load_dwordx4 a[204:207], v1, s[12:15], s50 offen offset:3072
buffer_load_dwordx4 a[208:211], v1, s[12:15], s51 offen offset:0
buffer_load_dwordx4 a[212:215], v1, s[12:15], s51 offen offset:1024
buffer_load_dwordx4 a[216:219], v1, s[12:15], s51 offen offset:2048
buffer_load_dwordx4 a[220:223], v1, s[12:15], s51 offen offset:3072
v_mov_b32 v136, -1
v_mov_b32 v137, -1
v_mov_b32 v138, -1
v_mov_b32 v139, -1
buffer_store_dwordx4 v[136:139], v1, s[12:15], s44 offen sc1
buffer_store_dwordx4 v[136:139], v1, s[12:15], s44 offen offset:1024 sc1
buffer_store_dword v136, v19, s[12:15], s45 offen sc1
s_waitcnt vmcnt(18) lgkmcnt(6)
v_mfma_f32_32x32x16_bf16 v[16:31], a[160:163], a[96:99], 0
buffer_load_dwordx4 a[224:227], v2, s[12:15], s48 offen offset:0
v_mfma_f32_32x32x16_bf16 v[32:47], a[160:163], a[128:131], 0
ds_read_b128 a[112:115], v8 offset:4096
ds_read_b128 a[144:147], v8 offset:12288
s_waitcnt vmcnt(18) lgkmcnt(6)
v_mfma_f32_32x32x16_bf16 v[16:31], a[164:167], a[100:103], v[16:31]
buffer_load_dwordx4 a[228:231], v3, s[12:15], s48 offen offset:0
v_mfma_f32_32x32x16_bf16 v[32:47], a[164:167], a[132:135], v[32:47]
ds_read_b128 a[116:119], v9 offset:5120
ds_read_b128 a[148:151], v9 offset:13312
s_waitcnt vmcnt(18) lgkmcnt(6)
v_mfma_f32_32x32x16_bf16 v[16:31], a[168:171], a[104:107], v[16:31]
buffer_load_dwordx4 a[232:235], v4, s[12:15], s48 offen offset:0
v_mfma_f32_32x32x16_bf16 v[32:47], a[168:171], a[136:139], v[32:47]
ds_read_b128 a[120:123], v10 offset:6144
ds_read_b128 a[152:155], v10 offset:14336
s_waitcnt vmcnt(18) lgkmcnt(6)
v_mfma_f32_32x32x16_bf16 v[16:31], a[172:175], a[108:111], v[16:31]
buffer_load_dwordx4 a[236:239], v5, s[12:15], s48 offen offset:0
v_mfma_f32_32x32x16_bf16 v[32:47], a[172:175], a[140:143], v[32:47]
ds_read_b128 a[124:127], v11 offset:7168
ds_read_b128 a[156:159], v11 offset:15360
s_waitcnt vmcnt(18) lgkmcnt(6)
v_mfma_f32_32x32x16_bf16 v[16:31], a[176:179], a[112:115], v[16:31]
buffer_load_dwordx4 a[240:243], v2, s[12:15], s48 offen offset:1024
v_mfma_f32_32x32x16_bf16 v[32:47], a[176:179], a[144:147], v[32:47]
s_waitcnt vmcnt(18) lgkmcnt(4)
v_mfma_f32_32x32x16_bf16 v[16:31], a[180:183], a[116:119], v[16:31]
buffer_load_dwordx4 a[244:247], v3, s[12:15], s48 offen offset:1024
v_mfma_f32_32x32x16_bf16 v[32:47], a[180:183], a[148:151], v[32:47]
s_waitcnt vmcnt(18) lgkmcnt(2)
v_mfma_f32_32x32x16_bf16 v[16:31], a[184:187], a[120:123], v[16:31]
buffer_load_dwordx4 a[248:251], v4, s[12:15], s48 offen offset:1024
v_mfma_f32_32x32x16_bf16 v[32:47], a[184:187], a[152:155], v[32:47]
s_waitcnt vmcnt(18) lgkmcnt(0)
v_mfma_f32_32x32x16_bf16 v[16:31], a[188:191], a[124:127], v[16:31]
buffer_load_dwordx4 a[252:255], v5, s[12:15], s48 offen offset:1024
v_mfma_f32_32x32x16_bf16 v[32:47], a[188:191], a[156:159], v[32:47]
s_waitcnt vmcnt(18)
v_mfma_f32_32x32x16_bf16 v[48:63], a[192:195], a[96:99], 0
buffer_load_dwordx4 v[144:147], v1, s[12:15], s52 offen offset:0
v_mfma_f32_32x32x16_bf16 v[64:79], a[192:195], a[128:131], 0
s_waitcnt vmcnt(18)
v_mfma_f32_32x32x16_bf16 v[48:63], a[196:199], a[100:103], v[48:63]
buffer_load_dwordx4 v[148:151], v1, s[12:15], s52 offen offset:1024
v_mfma_f32_32x32x16_bf16 v[64:79], a[196:199], a[132:135], v[64:79]
s_waitcnt vmcnt(18)
v_mfma_f32_32x32x16_bf16 v[48:63], a[200:203], a[104:107], v[48:63]
buffer_load_dwordx4 v[152:155], v1, s[12:15], s52 offen offset:2048
v_exp_f32 v16, v16
v_mfma_f32_32x32x16_bf16 v[64:79], a[200:203], a[136:139], v[64:79]
v_exp_f32 v17, v17
v_add_f32 v6, v6, v16
s_waitcnt vmcnt(18)
v_mfma_f32_32x32x16_bf16 v[48:63], a[204:207], a[108:111], v[48:63]
buffer_load_dwordx4 v[156:159], v1, s[12:15], s52 offen offset:3072
v_exp_f32 v18, v18
v_add_f32 v6, v6, v17
v_cvt_pk_bf16_f32 v80, v16, v17
v_mfma_f32_32x32x16_bf16 v[64:79], a[204:207], a[140:143], v[64:79]
v_exp_f32 v19, v19
v_add_f32 v6, v6, v18
s_waitcnt vmcnt(18)
v_mfma_f32_32x32x16_bf16 v[48:63], a[208:211], a[112:115], v[48:63]
buffer_load_dwordx4 v[160:163], v1, s[12:15], s53 offen offset:0
v_exp_f32 v20, v20
v_add_f32 v6, v6, v19
v_cvt_pk_bf16_f32 v81, v18, v19
v_mfma_f32_32x32x16_bf16 v[64:79], a[208:211], a[144:147], v[64:79]
v_exp_f32 v21, v21
v_add_f32 v6, v6, v20
s_waitcnt vmcnt(18)
v_mfma_f32_32x32x16_bf16 v[48:63], a[212:215], a[116:119], v[48:63]
buffer_load_dwordx4 v[164:167], v1, s[12:15], s53 offen offset:1024
v_exp_f32 v22, v22
v_add_f32 v6, v6, v21
v_exp_f32 v23, v23
v_cvt_pk_bf16_f32 v82, v20, v21
v_mfma_f32_32x32x16_bf16 v[64:79], a[212:215], a[148:151], v[64:79]
v_exp_f32 v32, v32
v_add_f32 v6, v6, v22
v_exp_f32 v33, v33
v_add_f32 v6, v6, v23
v_cvt_pk_bf16_f32 v83, v22, v23
s_waitcnt vmcnt(18)
v_mfma_f32_32x32x16_bf16 v[48:63], a[216:219], a[120:123], v[48:63]
buffer_load_dwordx4 v[168:171], v1, s[12:15], s53 offen offset:2048
v_exp_f32 v34, v34
v_add_f32 v7, v7, v32
v_exp_f32 v35, v35
v_add_f32 v7, v7, v33
v_cvt_pk_bf16_f32 v88, v32, v33
v_mfma_f32_32x32x16_bf16 v[64:79], a[216:219], a[152:155], v[64:79]
v_exp_f32 v36, v36
v_add_f32 v7, v7, v34
v_exp_f32 v37, v37
v_add_f32 v7, v7, v35
v_cvt_pk_bf16_f32 v89, v34, v35
s_waitcnt vmcnt(18)
v_mfma_f32_32x32x16_bf16 v[48:63], a[220:223], a[124:127], v[48:63]
buffer_load_dwordx4 v[172:175], v1, s[12:15], s53 offen offset:3072
v_exp_f32 v38, v38
v_add_f32 v7, v7, v36
v_exp_f32 v39, v39
v_add_f32 v7, v7, v37
v_cvt_pk_bf16_f32 v90, v36, v37
v_mfma_f32_32x32x16_bf16 v[64:79], a[220:223], a[156:159], v[64:79]
v_exp_f32 v24, v24
v_add_f32 v7, v7, v38
v_exp_f32 v25, v25
v_add_f32 v7, v7, v39
v_cvt_pk_bf16_f32 v91, v38, v39
s_waitcnt vmcnt(15)
v_mfma_f32_32x32x16_bf16 v[112:127], a[224:227], v[80:83], 0
buffer_load_dwordx4 a[160:163], v2, s[12:15], s50 offen offset:0
v_exp_f32 v26, v26
v_add_f32 v6, v6, v24
v_exp_f32 v27, v27
v_add_f32 v6, v6, v25
v_cvt_pk_bf16_f32 v84, v24, v25
v_mfma_f32_32x32x16_bf16 v[128:143], a[224:227], v[88:91], 0
v_exp_f32 v28, v28
v_add_f32 v6, v6, v26
v_exp_f32 v29, v29
v_add_f32 v6, v6, v27
v_cvt_pk_bf16_f32 v85, v26, v27
s_waitcnt vmcnt(15)
v_mfma_f32_32x32x16_bf16 a[0:15], a[228:231], v[80:83], 0
buffer_load_dwordx4 a[164:167], v3, s[12:15], s50 offen offset:0
v_exp_f32 v30, v30
v_add_f32 v6, v6, v28
v_exp_f32 v31, v31
v_add_f32 v6, v6, v29
v_cvt_pk_bf16_f32 v86, v28, v29
v_mfma_f32_32x32x16_bf16 a[48:63], a[228:231], v[88:91], 0
v_exp_f32 v40, v40
v_add_f32 v6, v6, v30
v_exp_f32 v41, v41
v_add_f32 v6, v6, v31
v_cvt_pk_bf16_f32 v87, v30, v31
s_waitcnt vmcnt(15)
v_mfma_f32_32x32x16_bf16 a[16:31], a[232:235], v[80:83], 0
buffer_load_dwordx4 a[168:171], v4, s[12:15], s50 offen offset:0
v_exp_f32 v42, v42
v_add_f32 v7, v7, v40
v_exp_f32 v43, v43
v_add_f32 v7, v7, v41
v_cvt_pk_bf16_f32 v92, v40, v41
v_mfma_f32_32x32x16_bf16 a[64:79], a[232:235], v[88:91], 0
v_exp_f32 v44, v44
v_add_f32 v7, v7, v42
v_exp_f32 v45, v45
v_add_f32 v7, v7, v43
v_cvt_pk_bf16_f32 v93, v42, v43
s_waitcnt vmcnt(15)
v_mfma_f32_32x32x16_bf16 a[32:47], a[236:239], v[80:83], 0
buffer_load_dwordx4 a[172:175], v5, s[12:15], s50 offen offset:0
v_exp_f32 v46, v46
v_add_f32 v7, v7, v44
v_exp_f32 v47, v47
v_add_f32 v7, v7, v45
v_cvt_pk_bf16_f32 v94, v44, v45
v_mfma_f32_32x32x16_bf16 a[80:95], a[236:239], v[88:91], 0
v_exp_f32 v48, v48
v_add_f32 v7, v7, v46
v_add_f32 v7, v7, v47
v_cvt_pk_bf16_f32 v95, v46, v47
s_waitcnt vmcnt(15)
v_mfma_f32_32x32x16_bf16 v[112:127], a[240:243], v[84:87], v[112:127]
buffer_load_dwordx4 a[176:179], v2, s[12:15], s50 offen offset:1024
v_exp_f32 v49, v49
v_add_f32 v6, v6, v48
v_mfma_f32_32x32x16_bf16 v[128:143], a[240:243], v[92:95], v[128:143]
v_exp_f32 v50, v50
v_add_f32 v6, v6, v49
v_cvt_pk_bf16_f32 v96, v48, v49
s_waitcnt vmcnt(15)
v_mfma_f32_32x32x16_bf16 a[0:15], a[244:247], v[84:87], a[0:15]
buffer_load_dwordx4 a[180:183], v3, s[12:15], s50 offen offset:1024
v_exp_f32 v51, v51
v_add_f32 v6, v6, v50
v_mfma_f32_32x32x16_bf16 a[48:63], a[244:247], v[92:95], a[48:63]
v_exp_f32 v52, v52
v_add_f32 v6, v6, v51
v_cvt_pk_bf16_f32 v97, v50, v51
s_waitcnt vmcnt(15)
v_mfma_f32_32x32x16_bf16 a[16:31], a[248:251], v[84:87], a[16:31]
buffer_load_dwordx4 a[184:187], v4, s[12:15], s50 offen offset:1024
v_exp_f32 v53, v53
v_add_f32 v6, v6, v52
v_mfma_f32_32x32x16_bf16 a[64:79], a[248:251], v[92:95], a[64:79]
v_exp_f32 v54, v54
v_add_f32 v6, v6, v53
v_cvt_pk_bf16_f32 v98, v52, v53
s_waitcnt vmcnt(15)
v_mfma_f32_32x32x16_bf16 a[32:47], a[252:255], v[84:87], a[32:47]
buffer_load_dwordx4 a[188:191], v5, s[12:15], s50 offen offset:1024
v_exp_f32 v55, v55
v_add_f32 v6, v6, v54
v_mfma_f32_32x32x16_bf16 a[80:95], a[252:255], v[92:95], a[80:95]
v_exp_f32 v64, v64
v_add_f32 v6, v6, v55
v_cvt_pk_bf16_f32 v99, v54, v55
s_waitcnt vmcnt(15)
v_mfma_f32_32x32x16_bf16 v[16:31], v[144:147], a[96:99], 0
buffer_load_dwordx4 a[192:195], v1, s[12:15], s54 offen offset:0
v_exp_f32 v65, v65
v_add_f32 v7, v7, v64
v_mfma_f32_32x32x16_bf16 v[32:47], v[144:147], a[128:131], 0
v_exp_f32 v66, v66
v_add_f32 v7, v7, v65
v_cvt_pk_bf16_f32 v104, v64, v65
s_waitcnt vmcnt(15)
v_mfma_f32_32x32x16_bf16 v[16:31], v[148:151], a[100:103], v[16:31]
buffer_load_dwordx4 a[196:199], v1, s[12:15], s54 offen offset:1024
v_exp_f32 v67, v67
v_add_f32 v7, v7, v66
v_mfma_f32_32x32x16_bf16 v[32:47], v[148:151], a[132:135], v[32:47]
v_exp_f32 v68, v68
v_add_f32 v7, v7, v67
v_cvt_pk_bf16_f32 v105, v66, v67
s_waitcnt vmcnt(15)
v_mfma_f32_32x32x16_bf16 v[16:31], v[152:155], a[104:107], v[16:31]
buffer_load_dwordx4 a[200:203], v1, s[12:15], s54 offen offset:2048
v_exp_f32 v69, v69
v_add_f32 v7, v7, v68
v_mfma_f32_32x32x16_bf16 v[32:47], v[152:155], a[136:139], v[32:47]
v_exp_f32 v70, v70
v_add_f32 v7, v7, v69
v_cvt_pk_bf16_f32 v106, v68, v69
s_waitcnt vmcnt(15)
v_mfma_f32_32x32x16_bf16 v[16:31], v[156:159], a[108:111], v[16:31]
buffer_load_dwordx4 a[204:207], v1, s[12:15], s54 offen offset:3072
v_exp_f32 v71, v71
v_add_f32 v7, v7, v70
v_mfma_f32_32x32x16_bf16 v[32:47], v[156:159], a[140:143], v[32:47]
v_exp_f32 v56, v56
v_add_f32 v7, v7, v71
v_cvt_pk_bf16_f32 v107, v70, v71
s_waitcnt vmcnt(15)
v_mfma_f32_32x32x16_bf16 v[16:31], v[160:163], a[112:115], v[16:31]
buffer_load_dwordx4 a[208:211], v1, s[12:15], s55 offen offset:0
v_exp_f32 v57, v57
v_add_f32 v6, v6, v56
v_mfma_f32_32x32x16_bf16 v[32:47], v[160:163], a[144:147], v[32:47]
v_exp_f32 v58, v58
v_add_f32 v6, v6, v57
v_cvt_pk_bf16_f32 v100, v56, v57
s_waitcnt vmcnt(15)
v_mfma_f32_32x32x16_bf16 v[16:31], v[164:167], a[116:119], v[16:31]
buffer_load_dwordx4 a[212:215], v1, s[12:15], s55 offen offset:1024
v_exp_f32 v59, v59
v_add_f32 v6, v6, v58
v_mfma_f32_32x32x16_bf16 v[32:47], v[164:167], a[148:151], v[32:47]
v_exp_f32 v60, v60
v_add_f32 v6, v6, v59
v_cvt_pk_bf16_f32 v101, v58, v59
s_waitcnt vmcnt(15)
v_mfma_f32_32x32x16_bf16 v[16:31], v[168:171], a[120:123], v[16:31]
buffer_load_dwordx4 a[216:219], v1, s[12:15], s55 offen offset:2048
v_exp_f32 v61, v61
v_add_f32 v6, v6, v60
v_mfma_f32_32x32x16_bf16 v[32:47], v[168:171], a[152:155], v[32:47]
v_exp_f32 v62, v62
v_add_f32 v6, v6, v61
v_cvt_pk_bf16_f32 v102, v60, v61
s_waitcnt vmcnt(15)
v_mfma_f32_32x32x16_bf16 v[16:31], v[172:175], a[124:127], v[16:31]
buffer_load_dwordx4 a[220:223], v1, s[12:15], s55 offen offset:3072
v_exp_f32 v63, v63
v_add_f32 v6, v6, v62
v_mfma_f32_32x32x16_bf16 v[32:47], v[172:175], a[156:159], v[32:47]
v_exp_f32 v72, v72
v_add_f32 v6, v6, v63
v_cvt_pk_bf16_f32 v103, v62, v63
s_waitcnt vmcnt(15)
v_mfma_f32_32x32x16_bf16 v[112:127], a[160:163], v[96:99], v[112:127]
buffer_load_dwordx4 a[224:227], v2, s[12:15], s52 offen offset:0
v_exp_f32 v73, v73
v_add_f32 v7, v7, v72
v_mfma_f32_32x32x16_bf16 v[128:143], a[160:163], v[104:107], v[128:143]
v_exp_f32 v74, v74
v_add_f32 v7, v7, v73
v_cvt_pk_bf16_f32 v108, v72, v73
s_waitcnt vmcnt(15)
v_mfma_f32_32x32x16_bf16 a[0:15], a[164:167], v[96:99], a[0:15]
buffer_load_dwordx4 a[228:231], v3, s[12:15], s52 offen offset:0
v_exp_f32 v75, v75
v_add_f32 v7, v7, v74
v_mfma_f32_32x32x16_bf16 a[48:63], a[164:167], v[104:107], a[48:63]
v_exp_f32 v76, v76
v_add_f32 v7, v7, v75
v_cvt_pk_bf16_f32 v109, v74, v75
s_waitcnt vmcnt(15)
v_mfma_f32_32x32x16_bf16 a[16:31], a[168:171], v[96:99], a[16:31]
buffer_load_dwordx4 a[232:235], v4, s[12:15], s52 offen offset:0
v_exp_f32 v77, v77
v_add_f32 v7, v7, v76
v_mfma_f32_32x32x16_bf16 a[64:79], a[168:171], v[104:107], a[64:79]
v_exp_f32 v78, v78
v_add_f32 v7, v7, v77
v_cvt_pk_bf16_f32 v110, v76, v77
s_waitcnt vmcnt(15)
v_mfma_f32_32x32x16_bf16 a[32:47], a[172:175], v[96:99], a[32:47]
buffer_load_dwordx4 a[236:239], v5, s[12:15], s52 offen offset:0
v_exp_f32 v79, v79
v_add_f32 v7, v7, v78
v_mfma_f32_32x32x16_bf16 a[80:95], a[172:175], v[104:107], a[80:95]
v_exp_f32 v16, v16
v_add_f32 v7, v7, v79
v_cvt_pk_bf16_f32 v111, v78, v79
s_waitcnt vmcnt(15)
v_mfma_f32_32x32x16_bf16 v[112:127], a[176:179], v[100:103], v[112:127]
buffer_load_dwordx4 a[240:243], v2, s[12:15], s52 offen offset:1024
v_exp_f32 v17, v17
v_add_f32 v6, v6, v16
v_mfma_f32_32x32x16_bf16 v[128:143], a[176:179], v[108:111], v[128:143]
v_exp_f32 v18, v18
v_add_f32 v6, v6, v17
v_cvt_pk_bf16_f32 v80, v16, v17
s_waitcnt vmcnt(15)
v_mfma_f32_32x32x16_bf16 a[0:15], a[180:183], v[100:103], a[0:15]
buffer_load_dwordx4 a[244:247], v3, s[12:15], s52 offen offset:1024
v_exp_f32 v19, v19
v_add_f32 v6, v6, v18
v_mfma_f32_32x32x16_bf16 a[48:63], a[180:183], v[108:111], a[48:63]
v_exp_f32 v20, v20
v_add_f32 v6, v6, v19
v_cvt_pk_bf16_f32 v81, v18, v19
s_waitcnt vmcnt(15)
v_mfma_f32_32x32x16_bf16 a[16:31], a[184:187], v[100:103], a[16:31]
buffer_load_dwordx4 a[248:251], v4, s[12:15], s52 offen offset:1024
v_exp_f32 v21, v21
v_add_f32 v6, v6, v20
v_mfma_f32_32x32x16_bf16 a[64:79], a[184:187], v[108:111], a[64:79]
v_exp_f32 v22, v22
v_add_f32 v6, v6, v21
v_cvt_pk_bf16_f32 v82, v20, v21
s_waitcnt vmcnt(15)
v_mfma_f32_32x32x16_bf16 a[32:47], a[188:191], v[100:103], a[32:47]
buffer_load_dwordx4 a[252:255], v5, s[12:15], s52 offen offset:1024
v_exp_f32 v23, v23
v_add_f32 v6, v6, v22
v_mfma_f32_32x32x16_bf16 a[80:95], a[188:191], v[108:111], a[80:95]
v_exp_f32 v32, v32
v_add_f32 v6, v6, v23
v_cvt_pk_bf16_f32 v83, v22, v23
s_waitcnt vmcnt(15)
v_mfma_f32_32x32x16_bf16 v[48:63], a[192:195], a[96:99], 0
buffer_load_dwordx4 v[144:147], v1, s[12:15], s56 offen offset:0
v_exp_f32 v33, v33
v_add_f32 v7, v7, v32
v_mfma_f32_32x32x16_bf16 v[64:79], a[192:195], a[128:131], 0
v_exp_f32 v34, v34
v_add_f32 v7, v7, v33
v_cvt_pk_bf16_f32 v88, v32, v33
s_waitcnt vmcnt(15)
v_mfma_f32_32x32x16_bf16 v[48:63], a[196:199], a[100:103], v[48:63]
buffer_load_dwordx4 v[148:151], v1, s[12:15], s56 offen offset:1024
v_exp_f32 v35, v35
v_add_f32 v7, v7, v34
v_mfma_f32_32x32x16_bf16 v[64:79], a[196:199], a[132:135], v[64:79]
v_exp_f32 v36, v36
v_add_f32 v7, v7, v35
v_cvt_pk_bf16_f32 v89, v34, v35
s_waitcnt vmcnt(15)
v_mfma_f32_32x32x16_bf16 v[48:63], a[200:203], a[104:107], v[48:63]
buffer_load_dwordx4 v[152:155], v1, s[12:15], s56 offen offset:2048
v_exp_f32 v37, v37
v_add_f32 v7, v7, v36
v_mfma_f32_32x32x16_bf16 v[64:79], a[200:203], a[136:139], v[64:79]
v_exp_f32 v38, v38
v_add_f32 v7, v7, v37
v_cvt_pk_bf16_f32 v90, v36, v37
s_waitcnt vmcnt(15)
v_mfma_f32_32x32x16_bf16 v[48:63], a[204:207], a[108:111], v[48:63]
buffer_load_dwordx4 v[156:159], v1, s[12:15], s56 offen offset:3072
v_exp_f32 v39, v39
v_add_f32 v7, v7, v38
v_mfma_f32_32x32x16_bf16 v[64:79], a[204:207], a[140:143], v[64:79]
v_exp_f32 v24, v24
v_add_f32 v7, v7, v39
v_cvt_pk_bf16_f32 v91, v38, v39
s_waitcnt vmcnt(15)
v_mfma_f32_32x32x16_bf16 v[48:63], a[208:211], a[112:115], v[48:63]
buffer_load_dwordx4 v[160:163], v1, s[12:15], s57 offen offset:0
v_exp_f32 v25, v25
v_add_f32 v6, v6, v24
v_mfma_f32_32x32x16_bf16 v[64:79], a[208:211], a[144:147], v[64:79]
v_exp_f32 v26, v26
v_add_f32 v6, v6, v25
v_cvt_pk_bf16_f32 v84, v24, v25
s_waitcnt vmcnt(15)
v_mfma_f32_32x32x16_bf16 v[48:63], a[212:215], a[116:119], v[48:63]
buffer_load_dwordx4 v[164:167], v1, s[12:15], s57 offen offset:1024
v_exp_f32 v27, v27
v_add_f32 v6, v6, v26
v_mfma_f32_32x32x16_bf16 v[64:79], a[212:215], a[148:151], v[64:79]
v_exp_f32 v28, v28
v_add_f32 v6, v6, v27
v_cvt_pk_bf16_f32 v85, v26, v27
s_waitcnt vmcnt(15)
v_mfma_f32_32x32x16_bf16 v[48:63], a[216:219], a[120:123], v[48:63]
buffer_load_dwordx4 v[168:171], v1, s[12:15], s57 offen offset:2048
v_exp_f32 v29, v29
v_add_f32 v6, v6, v28
v_mfma_f32_32x32x16_bf16 v[64:79], a[216:219], a[152:155], v[64:79]
v_exp_f32 v30, v30
v_add_f32 v6, v6, v29
v_cvt_pk_bf16_f32 v86, v28, v29
s_waitcnt vmcnt(15)
v_mfma_f32_32x32x16_bf16 v[48:63], a[220:223], a[124:127], v[48:63]
buffer_load_dwordx4 v[172:175], v1, s[12:15], s57 offen offset:3072
v_exp_f32 v31, v31
v_add_f32 v6, v6, v30
v_mfma_f32_32x32x16_bf16 v[64:79], a[220:223], a[156:159], v[64:79]
v_exp_f32 v40, v40
v_add_f32 v6, v6, v31
v_cvt_pk_bf16_f32 v87, v30, v31
s_waitcnt vmcnt(15)
v_mfma_f32_32x32x16_bf16 v[112:127], a[224:227], v[80:83], v[112:127]
buffer_load_dwordx4 a[160:163], v2, s[12:15], s54 offen offset:0
v_exp_f32 v41, v41
v_add_f32 v7, v7, v40
v_mfma_f32_32x32x16_bf16 v[128:143], a[224:227], v[88:91], v[128:143]
v_exp_f32 v42, v42
v_add_f32 v7, v7, v41
v_cvt_pk_bf16_f32 v92, v40, v41
s_waitcnt vmcnt(15)
v_mfma_f32_32x32x16_bf16 a[0:15], a[228:231], v[80:83], a[0:15]
buffer_load_dwordx4 a[164:167], v3, s[12:15], s54 offen offset:0
v_exp_f32 v43, v43
v_add_f32 v7, v7, v42
v_mfma_f32_32x32x16_bf16 a[48:63], a[228:231], v[88:91], a[48:63]
v_exp_f32 v44, v44
v_add_f32 v7, v7, v43
v_cvt_pk_bf16_f32 v93, v42, v43
s_waitcnt vmcnt(15)
v_mfma_f32_32x32x16_bf16 a[16:31], a[232:235], v[80:83], a[16:31]
buffer_load_dwordx4 a[168:171], v4, s[12:15], s54 offen offset:0
v_exp_f32 v45, v45
v_add_f32 v7, v7, v44
v_mfma_f32_32x32x16_bf16 a[64:79], a[232:235], v[88:91], a[64:79]
v_exp_f32 v46, v46
v_add_f32 v7, v7, v45
v_cvt_pk_bf16_f32 v94, v44, v45
s_waitcnt vmcnt(15)
v_mfma_f32_32x32x16_bf16 a[32:47], a[236:239], v[80:83], a[32:47]
buffer_load_dwordx4 a[172:175], v5, s[12:15], s54 offen offset:0
v_exp_f32 v47, v47
v_add_f32 v7, v7, v46
v_mfma_f32_32x32x16_bf16 a[80:95], a[236:239], v[88:91], a[80:95]
v_exp_f32 v48, v48
v_add_f32 v7, v7, v47
v_cvt_pk_bf16_f32 v95, v46, v47
s_waitcnt vmcnt(15)
v_mfma_f32_32x32x16_bf16 v[112:127], a[240:243], v[84:87], v[112:127]
buffer_load_dwordx4 a[176:179], v2, s[12:15], s54 offen offset:1024
v_exp_f32 v49, v49
v_add_f32 v6, v6, v48
v_mfma_f32_32x32x16_bf16 v[128:143], a[240:243], v[92:95], v[128:143]
v_exp_f32 v50, v50
v_add_f32 v6, v6, v49
v_cvt_pk_bf16_f32 v96, v48, v49
s_waitcnt vmcnt(15)
v_mfma_f32_32x32x16_bf16 a[0:15], a[244:247], v[84:87], a[0:15]
buffer_load_dwordx4 a[180:183], v3, s[12:15], s54 offen offset:1024
v_exp_f32 v51, v51
v_add_f32 v6, v6, v50
v_mfma_f32_32x32x16_bf16 a[48:63], a[244:247], v[92:95], a[48:63]
v_exp_f32 v52, v52
v_add_f32 v6, v6, v51
v_cvt_pk_bf16_f32 v97, v50, v51
s_waitcnt vmcnt(15)
v_mfma_f32_32x32x16_bf16 a[16:31], a[248:251], v[84:87], a[16:31]
buffer_load_dwordx4 a[184:187], v4, s[12:15], s54 offen offset:1024
v_exp_f32 v53, v53
v_add_f32 v6, v6, v52
v_mfma_f32_32x32x16_bf16 a[64:79], a[248:251], v[92:95], a[64:79]
v_exp_f32 v54, v54
v_add_f32 v6, v6, v53
v_cvt_pk_bf16_f32 v98, v52, v53
s_waitcnt vmcnt(15)
v_mfma_f32_32x32x16_bf16 a[32:47], a[252:255], v[84:87], a[32:47]
buffer_load_dwordx4 a[188:191], v5, s[12:15], s54 offen offset:1024
v_exp_f32 v55, v55
v_add_f32 v6, v6, v54
v_mfma_f32_32x32x16_bf16 a[80:95], a[252:255], v[92:95], a[80:95]
v_exp_f32 v64, v64
v_add_f32 v6, v6, v55
v_cvt_pk_bf16_f32 v99, v54, v55
s_waitcnt vmcnt(15)
v_mfma_f32_32x32x16_bf16 v[16:31], v[144:147], a[96:99], 0
buffer_load_dwordx4 a[192:195], v1, s[12:15], s58 offen offset:0
v_exp_f32 v65, v65
v_add_f32 v7, v7, v64
v_mfma_f32_32x32x16_bf16 v[32:47], v[144:147], a[128:131], 0
v_exp_f32 v66, v66
v_add_f32 v7, v7, v65
v_cvt_pk_bf16_f32 v104, v64, v65
s_waitcnt vmcnt(15)
v_mfma_f32_32x32x16_bf16 v[16:31], v[148:151], a[100:103], v[16:31]
buffer_load_dwordx4 a[196:199], v1, s[12:15], s58 offen offset:1024
v_exp_f32 v67, v67
v_add_f32 v7, v7, v66
v_mfma_f32_32x32x16_bf16 v[32:47], v[148:151], a[132:135], v[32:47]
v_exp_f32 v68, v68
v_add_f32 v7, v7, v67
v_cvt_pk_bf16_f32 v105, v66, v67
s_waitcnt vmcnt(15)
v_mfma_f32_32x32x16_bf16 v[16:31], v[152:155], a[104:107], v[16:31]
buffer_load_dwordx4 a[200:203], v1, s[12:15], s58 offen offset:2048
v_exp_f32 v69, v69
v_add_f32 v7, v7, v68
v_mfma_f32_32x32x16_bf16 v[32:47], v[152:155], a[136:139], v[32:47]
v_exp_f32 v70, v70
v_add_f32 v7, v7, v69
v_cvt_pk_bf16_f32 v106, v68, v69
s_waitcnt vmcnt(15)
v_mfma_f32_32x32x16_bf16 v[16:31], v[156:159], a[108:111], v[16:31]
buffer_load_dwordx4 a[204:207], v1, s[12:15], s58 offen offset:3072
v_exp_f32 v71, v71
v_add_f32 v7, v7, v70
v_mfma_f32_32x32x16_bf16 v[32:47], v[156:159], a[140:143], v[32:47]
v_exp_f32 v56, v56
v_add_f32 v7, v7, v71
v_cvt_pk_bf16_f32 v107, v70, v71
s_waitcnt vmcnt(15)
v_mfma_f32_32x32x16_bf16 v[16:31], v[160:163], a[112:115], v[16:31]
buffer_load_dwordx4 a[208:211], v1, s[12:15], s59 offen offset:0
v_exp_f32 v57, v57
v_add_f32 v6, v6, v56
v_mfma_f32_32x32x16_bf16 v[32:47], v[160:163], a[144:147], v[32:47]
v_exp_f32 v58, v58
v_add_f32 v6, v6, v57
v_cvt_pk_bf16_f32 v100, v56, v57
s_waitcnt vmcnt(15)
v_mfma_f32_32x32x16_bf16 v[16:31], v[164:167], a[116:119], v[16:31]
buffer_load_dwordx4 a[212:215], v1, s[12:15], s59 offen offset:1024
v_exp_f32 v59, v59
v_add_f32 v6, v6, v58
v_mfma_f32_32x32x16_bf16 v[32:47], v[164:167], a[148:151], v[32:47]
v_exp_f32 v60, v60
v_add_f32 v6, v6, v59
v_cvt_pk_bf16_f32 v101, v58, v59
s_waitcnt vmcnt(15)
v_mfma_f32_32x32x16_bf16 v[16:31], v[168:171], a[120:123], v[16:31]
buffer_load_dwordx4 a[216:219], v1, s[12:15], s59 offen offset:2048
v_exp_f32 v61, v61
v_add_f32 v6, v6, v60
v_mfma_f32_32x32x16_bf16 v[32:47], v[168:171], a[152:155], v[32:47]
v_exp_f32 v62, v62
v_add_f32 v6, v6, v61
v_cvt_pk_bf16_f32 v102, v60, v61
s_waitcnt vmcnt(15)
v_mfma_f32_32x32x16_bf16 v[16:31], v[172:175], a[124:127], v[16:31]
buffer_load_dwordx4 a[220:223], v1, s[12:15], s59 offen offset:3072
v_exp_f32 v63, v63
v_add_f32 v6, v6, v62
v_mfma_f32_32x32x16_bf16 v[32:47], v[172:175], a[156:159], v[32:47]
v_exp_f32 v72, v72
v_add_f32 v6, v6, v63
v_cvt_pk_bf16_f32 v103, v62, v63
s_waitcnt vmcnt(15)
v_mfma_f32_32x32x16_bf16 v[112:127], a[160:163], v[96:99], v[112:127]
buffer_load_dwordx4 a[224:227], v2, s[12:15], s56 offen offset:0
v_exp_f32 v73, v73
v_add_f32 v7, v7, v72
v_mfma_f32_32x32x16_bf16 v[128:143], a[160:163], v[104:107], v[128:143]
v_exp_f32 v74, v74
v_add_f32 v7, v7, v73
v_cvt_pk_bf16_f32 v108, v72, v73
s_waitcnt vmcnt(15)
v_mfma_f32_32x32x16_bf16 a[0:15], a[164:167], v[96:99], a[0:15]
buffer_load_dwordx4 a[228:231], v3, s[12:15], s56 offen offset:0
v_exp_f32 v75, v75
v_add_f32 v7, v7, v74
v_mfma_f32_32x32x16_bf16 a[48:63], a[164:167], v[104:107], a[48:63]
v_exp_f32 v76, v76
v_add_f32 v7, v7, v75
v_cvt_pk_bf16_f32 v109, v74, v75
s_waitcnt vmcnt(15)
v_mfma_f32_32x32x16_bf16 a[16:31], a[168:171], v[96:99], a[16:31]
buffer_load_dwordx4 a[232:235], v4, s[12:15], s56 offen offset:0
v_exp_f32 v77, v77
v_add_f32 v7, v7, v76
v_mfma_f32_32x32x16_bf16 a[64:79], a[168:171], v[104:107], a[64:79]
v_exp_f32 v78, v78
v_add_f32 v7, v7, v77
v_cvt_pk_bf16_f32 v110, v76, v77
s_waitcnt vmcnt(15)
v_mfma_f32_32x32x16_bf16 a[32:47], a[172:175], v[96:99], a[32:47]
buffer_load_dwordx4 a[236:239], v5, s[12:15], s56 offen offset:0
v_exp_f32 v79, v79
v_add_f32 v7, v7, v78
v_mfma_f32_32x32x16_bf16 a[80:95], a[172:175], v[104:107], a[80:95]
v_exp_f32 v16, v16
v_add_f32 v7, v7, v79
v_cvt_pk_bf16_f32 v111, v78, v79
s_waitcnt vmcnt(15)
v_mfma_f32_32x32x16_bf16 v[112:127], a[176:179], v[100:103], v[112:127]
buffer_load_dwordx4 a[240:243], v2, s[12:15], s56 offen offset:1024
v_exp_f32 v17, v17
v_add_f32 v6, v6, v16
v_mfma_f32_32x32x16_bf16 v[128:143], a[176:179], v[108:111], v[128:143]
v_exp_f32 v18, v18
v_add_f32 v6, v6, v17
v_cvt_pk_bf16_f32 v80, v16, v17
s_waitcnt vmcnt(15)
v_mfma_f32_32x32x16_bf16 a[0:15], a[180:183], v[100:103], a[0:15]
buffer_load_dwordx4 a[244:247], v3, s[12:15], s56 offen offset:1024
v_exp_f32 v19, v19
v_add_f32 v6, v6, v18
v_mfma_f32_32x32x16_bf16 a[48:63], a[180:183], v[108:111], a[48:63]
v_exp_f32 v20, v20
v_add_f32 v6, v6, v19
v_cvt_pk_bf16_f32 v81, v18, v19
s_waitcnt vmcnt(15)
v_mfma_f32_32x32x16_bf16 a[16:31], a[184:187], v[100:103], a[16:31]
buffer_load_dwordx4 a[248:251], v4, s[12:15], s56 offen offset:1024
v_exp_f32 v21, v21
v_add_f32 v6, v6, v20
v_mfma_f32_32x32x16_bf16 a[64:79], a[184:187], v[108:111], a[64:79]
v_exp_f32 v22, v22
v_add_f32 v6, v6, v21
v_cvt_pk_bf16_f32 v82, v20, v21
s_waitcnt vmcnt(15)
v_mfma_f32_32x32x16_bf16 a[32:47], a[188:191], v[100:103], a[32:47]
buffer_load_dwordx4 a[252:255], v5, s[12:15], s56 offen offset:1024
v_exp_f32 v23, v23
v_add_f32 v6, v6, v22
v_mfma_f32_32x32x16_bf16 a[80:95], a[188:191], v[108:111], a[80:95]
v_exp_f32 v32, v32
v_add_f32 v6, v6, v23
v_cvt_pk_bf16_f32 v83, v22, v23
s_waitcnt vmcnt(15)
v_mfma_f32_32x32x16_bf16 v[48:63], a[192:195], a[96:99], 0
buffer_load_dwordx4 v[144:147], v1, s[12:15], s60 offen offset:0
v_exp_f32 v33, v33
v_add_f32 v7, v7, v32
v_mfma_f32_32x32x16_bf16 v[64:79], a[192:195], a[128:131], 0
v_exp_f32 v34, v34
v_add_f32 v7, v7, v33
v_cvt_pk_bf16_f32 v88, v32, v33
s_waitcnt vmcnt(15)
v_mfma_f32_32x32x16_bf16 v[48:63], a[196:199], a[100:103], v[48:63]
buffer_load_dwordx4 v[148:151], v1, s[12:15], s60 offen offset:1024
v_exp_f32 v35, v35
v_add_f32 v7, v7, v34
v_mfma_f32_32x32x16_bf16 v[64:79], a[196:199], a[132:135], v[64:79]
v_exp_f32 v36, v36
v_add_f32 v7, v7, v35
v_cvt_pk_bf16_f32 v89, v34, v35
s_waitcnt vmcnt(15)
v_mfma_f32_32x32x16_bf16 v[48:63], a[200:203], a[104:107], v[48:63]
buffer_load_dwordx4 v[152:155], v1, s[12:15], s60 offen offset:2048
v_exp_f32 v37, v37
v_add_f32 v7, v7, v36
v_mfma_f32_32x32x16_bf16 v[64:79], a[200:203], a[136:139], v[64:79]
v_exp_f32 v38, v38
v_add_f32 v7, v7, v37
v_cvt_pk_bf16_f32 v90, v36, v37
s_waitcnt vmcnt(15)
v_mfma_f32_32x32x16_bf16 v[48:63], a[204:207], a[108:111], v[48:63]
buffer_load_dwordx4 v[156:159], v1, s[12:15], s60 offen offset:3072
v_exp_f32 v39, v39
v_add_f32 v7, v7, v38
v_mfma_f32_32x32x16_bf16 v[64:79], a[204:207], a[140:143], v[64:79]
v_exp_f32 v24, v24
v_add_f32 v7, v7, v39
v_cvt_pk_bf16_f32 v91, v38, v39
s_waitcnt vmcnt(15)
v_mfma_f32_32x32x16_bf16 v[48:63], a[208:211], a[112:115], v[48:63]
buffer_load_dwordx4 v[160:163], v1, s[12:15], s61 offen offset:0
v_exp_f32 v25, v25
v_add_f32 v6, v6, v24
v_mfma_f32_32x32x16_bf16 v[64:79], a[208:211], a[144:147], v[64:79]
v_exp_f32 v26, v26
v_add_f32 v6, v6, v25
v_cvt_pk_bf16_f32 v84, v24, v25
s_waitcnt vmcnt(15)
v_mfma_f32_32x32x16_bf16 v[48:63], a[212:215], a[116:119], v[48:63]
buffer_load_dwordx4 v[164:167], v1, s[12:15], s61 offen offset:1024
v_exp_f32 v27, v27
v_add_f32 v6, v6, v26
v_mfma_f32_32x32x16_bf16 v[64:79], a[212:215], a[148:151], v[64:79]
v_exp_f32 v28, v28
v_add_f32 v6, v6, v27
v_cvt_pk_bf16_f32 v85, v26, v27
s_waitcnt vmcnt(15)
v_mfma_f32_32x32x16_bf16 v[48:63], a[216:219], a[120:123], v[48:63]
buffer_load_dwordx4 v[168:171], v1, s[12:15], s61 offen offset:2048
v_exp_f32 v29, v29
v_add_f32 v6, v6, v28
v_mfma_f32_32x32x16_bf16 v[64:79], a[216:219], a[152:155], v[64:79]
v_exp_f32 v30, v30
v_add_f32 v6, v6, v29
v_cvt_pk_bf16_f32 v86, v28, v29
s_waitcnt vmcnt(15)
v_mfma_f32_32x32x16_bf16 v[48:63], a[220:223], a[124:127], v[48:63]
buffer_load_dwordx4 v[172:175], v1, s[12:15], s61 offen offset:3072
v_exp_f32 v31, v31
v_add_f32 v6, v6, v30
v_mfma_f32_32x32x16_bf16 v[64:79], a[220:223], a[156:159], v[64:79]
v_exp_f32 v40, v40
v_add_f32 v6, v6, v31
v_cvt_pk_bf16_f32 v87, v30, v31
s_waitcnt vmcnt(15)
v_mfma_f32_32x32x16_bf16 v[112:127], a[224:227], v[80:83], v[112:127]
buffer_load_dwordx4 a[160:163], v2, s[12:15], s58 offen offset:0
v_exp_f32 v41, v41
v_add_f32 v7, v7, v40
v_mfma_f32_32x32x16_bf16 v[128:143], a[224:227], v[88:91], v[128:143]
v_exp_f32 v42, v42
v_add_f32 v7, v7, v41
v_cvt_pk_bf16_f32 v92, v40, v41
s_waitcnt vmcnt(15)
v_mfma_f32_32x32x16_bf16 a[0:15], a[228:231], v[80:83], a[0:15]
buffer_load_dwordx4 a[164:167], v3, s[12:15], s58 offen offset:0
v_exp_f32 v43, v43
v_add_f32 v7, v7, v42
v_mfma_f32_32x32x16_bf16 a[48:63], a[228:231], v[88:91], a[48:63]
v_exp_f32 v44, v44
v_add_f32 v7, v7, v43
v_cvt_pk_bf16_f32 v93, v42, v43
s_waitcnt vmcnt(15)
v_mfma_f32_32x32x16_bf16 a[16:31], a[232:235], v[80:83], a[16:31]
buffer_load_dwordx4 a[168:171], v4, s[12:15], s58 offen offset:0
v_exp_f32 v45, v45
v_add_f32 v7, v7, v44
v_mfma_f32_32x32x16_bf16 a[64:79], a[232:235], v[88:91], a[64:79]
v_exp_f32 v46, v46
v_add_f32 v7, v7, v45
v_cvt_pk_bf16_f32 v94, v44, v45
s_waitcnt vmcnt(15)
v_mfma_f32_32x32x16_bf16 a[32:47], a[236:239], v[80:83], a[32:47]
buffer_load_dwordx4 a[172:175], v5, s[12:15], s58 offen offset:0
v_exp_f32 v47, v47
v_add_f32 v7, v7, v46
v_mfma_f32_32x32x16_bf16 a[80:95], a[236:239], v[88:91], a[80:95]
v_exp_f32 v48, v48
v_add_f32 v7, v7, v47
v_cvt_pk_bf16_f32 v95, v46, v47
s_waitcnt vmcnt(15)
v_mfma_f32_32x32x16_bf16 v[112:127], a[240:243], v[84:87], v[112:127]
buffer_load_dwordx4 a[176:179], v2, s[12:15], s58 offen offset:1024
v_exp_f32 v49, v49
v_add_f32 v6, v6, v48
v_mfma_f32_32x32x16_bf16 v[128:143], a[240:243], v[92:95], v[128:143]
v_exp_f32 v50, v50
v_add_f32 v6, v6, v49
v_cvt_pk_bf16_f32 v96, v48, v49
s_waitcnt vmcnt(15)
v_mfma_f32_32x32x16_bf16 a[0:15], a[244:247], v[84:87], a[0:15]
buffer_load_dwordx4 a[180:183], v3, s[12:15], s58 offen offset:1024
v_exp_f32 v51, v51
v_add_f32 v6, v6, v50
v_mfma_f32_32x32x16_bf16 a[48:63], a[244:247], v[92:95], a[48:63]
v_exp_f32 v52, v52
v_add_f32 v6, v6, v51
v_cvt_pk_bf16_f32 v97, v50, v51
s_waitcnt vmcnt(15)
v_mfma_f32_32x32x16_bf16 a[16:31], a[248:251], v[84:87], a[16:31]
buffer_load_dwordx4 a[184:187], v4, s[12:15], s58 offen offset:1024
v_exp_f32 v53, v53
v_add_f32 v6, v6, v52
v_mfma_f32_32x32x16_bf16 a[64:79], a[248:251], v[92:95], a[64:79]
v_exp_f32 v54, v54
v_add_f32 v6, v6, v53
v_cvt_pk_bf16_f32 v98, v52, v53
s_waitcnt vmcnt(15)
v_mfma_f32_32x32x16_bf16 a[32:47], a[252:255], v[84:87], a[32:47]
buffer_load_dwordx4 a[188:191], v5, s[12:15], s58 offen offset:1024
v_exp_f32 v55, v55
v_add_f32 v6, v6, v54
v_mfma_f32_32x32x16_bf16 a[80:95], a[252:255], v[92:95], a[80:95]
v_exp_f32 v64, v64
v_add_f32 v6, v6, v55
v_cvt_pk_bf16_f32 v99, v54, v55
s_waitcnt vmcnt(15)
v_mfma_f32_32x32x16_bf16 v[16:31], v[144:147], a[96:99], 0
buffer_load_dwordx4 a[192:195], v1, s[12:15], s62 offen offset:0
v_exp_f32 v65, v65
v_add_f32 v7, v7, v64
v_mfma_f32_32x32x16_bf16 v[32:47], v[144:147], a[128:131], 0
v_exp_f32 v66, v66
v_add_f32 v7, v7, v65
v_cvt_pk_bf16_f32 v104, v64, v65
s_waitcnt vmcnt(15)
v_mfma_f32_32x32x16_bf16 v[16:31], v[148:151], a[100:103], v[16:31]
buffer_load_dwordx4 a[196:199], v1, s[12:15], s62 offen offset:1024
v_exp_f32 v67, v67
v_add_f32 v7, v7, v66
v_mfma_f32_32x32x16_bf16 v[32:47], v[148:151], a[132:135], v[32:47]
v_exp_f32 v68, v68
v_add_f32 v7, v7, v67
v_cvt_pk_bf16_f32 v105, v66, v67
s_waitcnt vmcnt(15)
v_mfma_f32_32x32x16_bf16 v[16:31], v[152:155], a[104:107], v[16:31]
buffer_load_dwordx4 a[200:203], v1, s[12:15], s62 offen offset:2048
v_exp_f32 v69, v69
v_add_f32 v7, v7, v68
v_mfma_f32_32x32x16_bf16 v[32:47], v[152:155], a[136:139], v[32:47]
v_exp_f32 v70, v70
v_add_f32 v7, v7, v69
v_cvt_pk_bf16_f32 v106, v68, v69
s_waitcnt vmcnt(15)
v_mfma_f32_32x32x16_bf16 v[16:31], v[156:159], a[108:111], v[16:31]
buffer_load_dwordx4 a[204:207], v1, s[12:15], s62 offen offset:3072
v_exp_f32 v71, v71
v_add_f32 v7, v7, v70
v_mfma_f32_32x32x16_bf16 v[32:47], v[156:159], a[140:143], v[32:47]
v_exp_f32 v56, v56
v_add_f32 v7, v7, v71
v_cvt_pk_bf16_f32 v107, v70, v71
s_waitcnt vmcnt(15)
v_mfma_f32_32x32x16_bf16 v[16:31], v[160:163], a[112:115], v[16:31]
buffer_load_dwordx4 a[208:211], v1, s[12:15], s63 offen offset:0
v_exp_f32 v57, v57
v_add_f32 v6, v6, v56
v_mfma_f32_32x32x16_bf16 v[32:47], v[160:163], a[144:147], v[32:47]
v_exp_f32 v58, v58
v_add_f32 v6, v6, v57
v_cvt_pk_bf16_f32 v100, v56, v57
s_waitcnt vmcnt(15)
v_mfma_f32_32x32x16_bf16 v[16:31], v[164:167], a[116:119], v[16:31]
buffer_load_dwordx4 a[212:215], v1, s[12:15], s63 offen offset:1024
v_exp_f32 v59, v59
v_add_f32 v6, v6, v58
v_mfma_f32_32x32x16_bf16 v[32:47], v[164:167], a[148:151], v[32:47]
v_exp_f32 v60, v60
v_add_f32 v6, v6, v59
v_cvt_pk_bf16_f32 v101, v58, v59
s_waitcnt vmcnt(15)
v_mfma_f32_32x32x16_bf16 v[16:31], v[168:171], a[120:123], v[16:31]
buffer_load_dwordx4 a[216:219], v1, s[12:15], s63 offen offset:2048
v_exp_f32 v61, v61
v_add_f32 v6, v6, v60
v_mfma_f32_32x32x16_bf16 v[32:47], v[168:171], a[152:155], v[32:47]
v_exp_f32 v62, v62
v_add_f32 v6, v6, v61
v_cvt_pk_bf16_f32 v102, v60, v61
s_waitcnt vmcnt(15)
v_mfma_f32_32x32x16_bf16 v[16:31], v[172:175], a[124:127], v[16:31]
buffer_load_dwordx4 a[220:223], v1, s[12:15], s63 offen offset:3072
v_exp_f32 v63, v63
v_add_f32 v6, v6, v62
v_mfma_f32_32x32x16_bf16 v[32:47], v[172:175], a[156:159], v[32:47]
v_exp_f32 v72, v72
v_add_f32 v6, v6, v63
v_cvt_pk_bf16_f32 v103, v62, v63
s_waitcnt vmcnt(15)
v_mfma_f32_32x32x16_bf16 v[112:127], a[160:163], v[96:99], v[112:127]
buffer_load_dwordx4 a[224:227], v2, s[12:15], s60 offen offset:0
v_exp_f32 v73, v73
v_add_f32 v7, v7, v72
v_mfma_f32_32x32x16_bf16 v[128:143], a[160:163], v[104:107], v[128:143]
v_exp_f32 v74, v74
v_add_f32 v7, v7, v73
v_cvt_pk_bf16_f32 v108, v72, v73
s_waitcnt vmcnt(15)
v_mfma_f32_32x32x16_bf16 a[0:15], a[164:167], v[96:99], a[0:15]
buffer_load_dwordx4 a[228:231], v3, s[12:15], s60 offen offset:0
v_exp_f32 v75, v75
v_add_f32 v7, v7, v74
v_mfma_f32_32x32x16_bf16 a[48:63], a[164:167], v[104:107], a[48:63]
v_exp_f32 v76, v76
v_add_f32 v7, v7, v75
v_cvt_pk_bf16_f32 v109, v74, v75
s_waitcnt vmcnt(15)
v_mfma_f32_32x32x16_bf16 a[16:31], a[168:171], v[96:99], a[16:31]
buffer_load_dwordx4 a[232:235], v4, s[12:15], s60 offen offset:0
v_exp_f32 v77, v77
v_add_f32 v7, v7, v76
v_mfma_f32_32x32x16_bf16 a[64:79], a[168:171], v[104:107], a[64:79]
v_exp_f32 v78, v78
v_add_f32 v7, v7, v77
v_cvt_pk_bf16_f32 v110, v76, v77
s_waitcnt vmcnt(15)
v_mfma_f32_32x32x16_bf16 a[32:47], a[172:175], v[96:99], a[32:47]
buffer_load_dwordx4 a[236:239], v5, s[12:15], s60 offen offset:0
v_exp_f32 v79, v79
v_add_f32 v7, v7, v78
v_mfma_f32_32x32x16_bf16 a[80:95], a[172:175], v[104:107], a[80:95]
v_exp_f32 v16, v16
v_add_f32 v7, v7, v79
v_cvt_pk_bf16_f32 v111, v78, v79
s_waitcnt vmcnt(15)
v_mfma_f32_32x32x16_bf16 v[112:127], a[176:179], v[100:103], v[112:127]
buffer_load_dwordx4 a[240:243], v2, s[12:15], s60 offen offset:1024
v_exp_f32 v17, v17
v_add_f32 v6, v6, v16
s_add_u32 s9, s3, 1
s_and_b32 s9, s9, 3
v_mfma_f32_32x32x16_bf16 v[128:143], a[176:179], v[108:111], v[128:143]
v_exp_f32 v18, v18
v_add_f32 v6, v6, v17
v_cvt_pk_bf16_f32 v80, v16, v17
s_mul_i32 s9, s9, 12288
s_add_u32 s9, s9, 16384
s_waitcnt vmcnt(15)
v_mfma_f32_32x32x16_bf16 a[0:15], a[180:183], v[100:103], a[0:15]
buffer_load_dwordx4 a[244:247], v3, s[12:15], s60 offen offset:1024
v_exp_f32 v19, v19
v_add_f32 v6, v6, v18
v_add_u32 v8, s9, v1
s_add_u32 s9, s3, 2
v_mfma_f32_32x32x16_bf16 a[48:63], a[180:183], v[108:111], a[48:63]
v_exp_f32 v20, v20
v_add_f32 v6, v6, v19
v_cvt_pk_bf16_f32 v81, v18, v19
s_and_b32 s9, s9, 3
s_mul_i32 s9, s9, 12288
s_waitcnt vmcnt(15)
v_mfma_f32_32x32x16_bf16 a[16:31], a[184:187], v[100:103], a[16:31]
buffer_load_dwordx4 a[248:251], v4, s[12:15], s60 offen offset:1024
v_exp_f32 v21, v21
v_add_f32 v6, v6, v20
s_add_u32 s9, s9, 20480
v_add_u32 v9, s9, v1
v_mfma_f32_32x32x16_bf16 a[64:79], a[184:187], v[108:111], a[64:79]
v_exp_f32 v22, v22
v_add_f32 v6, v6, v21
v_cvt_pk_bf16_f32 v82, v20, v21
s_add_u32 s9, s3, 3
s_and_b32 s9, s9, 3
s_waitcnt vmcnt(15)
v_mfma_f32_32x32x16_bf16 a[32:47], a[188:191], v[100:103], a[32:47]
buffer_load_dwordx4 a[252:255], v5, s[12:15], s60 offen offset:1024
v_exp_f32 v23, v23
v_add_f32 v6, v6, v22
s_mul_i32 s9, s9, 12288
s_add_u32 s9, s9, 24576
v_mfma_f32_32x32x16_bf16 a[80:95], a[188:191], v[108:111], a[80:95]
v_exp_f32 v24, v24
v_add_f32 v6, v6, v23
v_cvt_pk_bf16_f32 v83, v22, v23
v_add_u32 v10, s9, v1
s_mul_i32 s9, s3, 12288
s_waitcnt vmcnt(15)
v_mfma_f32_32x32x16_bf16 v[48:63], a[192:195], a[96:99], 0
buffer_load_dwordx4 v[144:147], v2, s[12:15], s62 offen offset:0
v_exp_f32 v25, v25
v_add_f32 v6, v6, v24
s_add_u32 s9, s9, 16384
v_add_u32 v11, s9, v1
v_mfma_f32_32x32x16_bf16 v[64:79], a[192:195], a[128:131], 0
v_exp_f32 v26, v26
v_add_f32 v6, v6, v25
v_cvt_pk_bf16_f32 v84, v24, v25
v_and_b32 v15, 31, v0
v_lshlrev_b32 v13, 5, v15
s_waitcnt vmcnt(15)
v_mfma_f32_32x32x16_bf16 v[48:63], a[196:199], a[100:103], v[48:63]
buffer_load_dwordx4 v[148:151], v3, s[12:15], s62 offen offset:0
v_exp_f32 v27, v27
v_add_f32 v6, v6, v26
v_add_u32 v13, 114688, v13
v_lshrrev_b32 v15, 5, v0
v_mfma_f32_32x32x16_bf16 v[64:79], a[196:199], a[132:135], v[64:79]
v_exp_f32 v28, v28
v_add_f32 v6, v6, v27
v_cvt_pk_bf16_f32 v85, v26, v27
v_lshl_add_u32 v12, v15, 2, v13
s_lshl_b32 s9, s3, 3
s_waitcnt vmcnt(15)
v_mfma_f32_32x32x16_bf16 v[48:63], a[200:203], a[104:107], v[48:63]
buffer_load_dwordx4 v[152:155], v4, s[12:15], s62 offen offset:0
v_exp_f32 v29, v29
v_add_f32 v6, v6, v28
v_add_u32 v12, s9, v12
v_lshlrev_b32 v14, 2, v0
v_mfma_f32_32x32x16_bf16 v[64:79], a[200:203], a[136:139], v[64:79]
v_exp_f32 v30, v30
v_add_f32 v6, v6, v29
v_cvt_pk_bf16_f32 v86, v28, v29
s_xor_b32 s46, s44, 8192
s_xor_b32 s47, s45, 1024
s_waitcnt vmcnt(15)
v_mfma_f32_32x32x16_bf16 v[48:63], a[204:207], a[108:111], v[48:63]
buffer_load_dwordx4 v[156:159], v5, s[12:15], s62 offen offset:0
v_exp_f32 v31, v31
v_add_f32 v6, v6, v30
s_lshl_b32 s9, s4, 6
s_lshl_b32 s10, s6, 1
v_mfma_f32_32x32x16_bf16 v[64:79], a[204:207], a[140:143], v[64:79]
v_exp_f32 v32, v32
v_add_f32 v6, v6, v31
v_cvt_pk_bf16_f32 v87, v30, v31
s_add_u32 s9, s9, s10
s_add_u32 s9, s9, s5
s_waitcnt vmcnt(15)
v_mfma_f32_32x32x16_bf16 v[48:63], a[208:211], a[112:115], v[48:63]
buffer_load_dwordx4 v[160:163], v2, s[12:15], s62 offen offset:1024
v_exp_f32 v33, v33
v_add_f32 v7, v7, v32
s_lshl_b32 s9, s9, 13
s_lshl_b32 s10, s3, 6
v_mfma_f32_32x32x16_bf16 v[64:79], a[208:211], a[144:147], v[64:79]
v_exp_f32 v34, v34
v_add_f32 v7, v7, v33
v_cvt_pk_bf16_f32 v88, v32, v33
s_add_u32 s42, s9, s10
v_and_b32 v15, 31, v0
s_waitcnt vmcnt(15)
v_mfma_f32_32x32x16_bf16 v[48:63], a[212:215], a[116:119], v[48:63]
buffer_load_dwordx4 v[164:167], v3, s[12:15], s62 offen offset:1024
v_exp_f32 v35, v35
v_add_f32 v7, v7, v34
v_lshlrev_b32 v15, 8, v15
s_mov_b32 s16, s40
v_mfma_f32_32x32x16_bf16 v[64:79], a[212:215], a[148:151], v[64:79]
v_exp_f32 v36, v36
v_add_f32 v7, v7, v35
v_cvt_pk_bf16_f32 v89, v34, v35
s_and_b32 s17, s41, 0xffff
s_mov_b32 s18, 2097152
s_waitcnt vmcnt(15)
v_mfma_f32_32x32x16_bf16 v[48:63], a[216:219], a[120:123], v[48:63]
buffer_load_dwordx4 v[168:171], v4, s[12:15], s62 offen offset:1024
v_exp_f32 v37, v37
v_add_f32 v7, v7, v36
s_mov_b32 s19, 0x20000
v_mfma_f32_32x32x16_bf16 v[64:79], a[216:219], a[152:155], v[64:79]
v_exp_f32 v38, v38
v_add_f32 v7, v7, v37
v_cvt_pk_bf16_f32 v90, v36, v37
s_waitcnt vmcnt(15)
v_mfma_f32_32x32x16_bf16 v[48:63], a[220:223], a[124:127], v[48:63]
buffer_load_dwordx4 v[172:175], v5, s[12:15], s62 offen offset:1024
v_exp_f32 v39, v39
v_add_f32 v7, v7, v38
v_mfma_f32_32x32x16_bf16 v[64:79], a[220:223], a[156:159], v[64:79]
v_exp_f32 v40, v40
v_add_f32 v7, v7, v39
v_cvt_pk_bf16_f32 v91, v38, v39
s_waitcnt vmcnt(15)
v_mfma_f32_32x32x16_bf16 v[112:127], a[224:227], v[80:83], v[112:127]
v_exp_f32 v41, v41
v_add_f32 v7, v7, v40
s_waitcnt vmcnt(14)
v_mfma_f32_32x32x16_bf16 a[0:15], a[228:231], v[80:83], a[0:15]
v_exp_f32 v42, v42
v_add_f32 v7, v7, v41
v_cvt_pk_bf16_f32 v92, v40, v41
s_waitcnt vmcnt(13)
v_mfma_f32_32x32x16_bf16 a[16:31], a[232:235], v[80:83], a[16:31]
v_exp_f32 v48, v48
v_add_f32 v7, v7, v42
v_exp_f32 v49, v49
s_waitcnt vmcnt(12)
v_mfma_f32_32x32x16_bf16 a[32:47], a[236:239], v[80:83], a[32:47]
v_exp_f32 v50, v50
v_add_f32 v6, v6, v48
v_exp_f32 v51, v51
v_add_f32 v6, v6, v49
v_cvt_pk_bf16_f32 v96, v48, v49
s_waitcnt vmcnt(11)
v_mfma_f32_32x32x16_bf16 v[112:127], a[240:243], v[84:87], v[112:127]
v_exp_f32 v52, v52
v_add_f32 v6, v6, v50
v_exp_f32 v53, v53
v_add_f32 v6, v6, v51
v_cvt_pk_bf16_f32 v97, v50, v51
s_waitcnt vmcnt(10)
v_mfma_f32_32x32x16_bf16 a[0:15], a[244:247], v[84:87], a[0:15]
v_exp_f32 v54, v54
v_add_f32 v6, v6, v52
v_exp_f32 v55, v55
v_add_f32 v6, v6, v53
v_cvt_pk_bf16_f32 v98, v52, v53
s_waitcnt vmcnt(9)
v_mfma_f32_32x32x16_bf16 a[16:31], a[248:251], v[84:87], a[16:31]
v_exp_f32 v56, v56
v_add_f32 v6, v6, v54
v_exp_f32 v57, v57
v_add_f32 v6, v6, v55
v_cvt_pk_bf16_f32 v99, v54, v55
s_waitcnt vmcnt(8)
v_mfma_f32_32x32x16_bf16 a[32:47], a[252:255], v[84:87], a[32:47]
v_exp_f32 v58, v58
v_add_f32 v6, v6, v56
v_exp_f32 v59, v59
v_add_f32 v6, v6, v57
v_cvt_pk_bf16_f32 v100, v56, v57
s_waitcnt vmcnt(7)
v_mfma_f32_32x32x16_bf16 v[112:127], v[144:147], v[96:99], v[112:127]
v_exp_f32 v60, v60
v_add_f32 v6, v6, v58
v_exp_f32 v61, v61
v_add_f32 v6, v6, v59
v_cvt_pk_bf16_f32 v101, v58, v59
s_waitcnt vmcnt(6)
v_mfma_f32_32x32x16_bf16 a[0:15], v[148:151], v[96:99], a[0:15]
v_exp_f32 v62, v62
v_add_f32 v6, v6, v60
v_exp_f32 v63, v63
v_add_f32 v6, v6, v61
v_cvt_pk_bf16_f32 v102, v60, v61
s_waitcnt vmcnt(5)
v_mfma_f32_32x32x16_bf16 a[16:31], v[152:155], v[96:99], a[16:31]
v_exp_f32 v43, v43
v_add_f32 v6, v6, v62
v_add_f32 v6, v6, v63
v_cvt_pk_bf16_f32 v103, v62, v63
s_waitcnt vmcnt(4)
v_mfma_f32_32x32x16_bf16 a[32:47], v[156:159], v[96:99], a[32:47]
v_exp_f32 v44, v44
v_add_f32 v7, v7, v43
v_cvt_pk_bf16_f32 v93, v42, v43
s_waitcnt vmcnt(3)
v_mfma_f32_32x32x16_bf16 v[112:127], v[160:163], v[100:103], v[112:127]
v_exp_f32 v45, v45
v_add_f32 v7, v7, v44
s_waitcnt vmcnt(2)
v_mfma_f32_32x32x16_bf16 a[0:15], v[164:167], v[100:103], a[0:15]
v_exp_f32 v46, v46
v_add_f32 v7, v7, v45
v_cvt_pk_bf16_f32 v94, v44, v45
s_waitcnt vmcnt(1)
v_mfma_f32_32x32x16_bf16 a[16:31], v[168:171], v[100:103], a[16:31]
v_exp_f32 v47, v47
v_add_f32 v7, v7, v46
s_waitcnt vmcnt(0)
v_mfma_f32_32x32x16_bf16 a[32:47], v[172:175], v[100:103], a[32:47]
v_exp_f32 v64, v64
v_add_f32 v7, v7, v47
v_cvt_pk_bf16_f32 v95, v46, v47
v_mfma_f32_32x32x16_bf16 v[128:143], a[224:227], v[88:91], v[128:143]
v_exp_f32 v65, v65
v_add_f32 v7, v7, v64
v_mfma_f32_32x32x16_bf16 a[48:63], a[228:231], v[88:91], a[48:63]
v_exp_f32 v66, v66
v_add_f32 v7, v7, v65
v_cvt_pk_bf16_f32 v104, v64, v65
v_mfma_f32_32x32x16_bf16 a[64:79], a[232:235], v[88:91], a[64:79]
v_exp_f32 v67, v67
v_add_f32 v7, v7, v66
ds_write_b32 v12, v6 offset:0
v_mfma_f32_32x32x16_bf16 a[80:95], a[236:239], v[88:91], a[80:95]
v_exp_f32 v68, v68
v_add_f32 v7, v7, v67
v_cvt_pk_bf16_f32 v105, v66, v67
ds_write_b128 v8, a[0:3] offset:0
v_mfma_f32_32x32x16_bf16 v[128:143], a[240:243], v[92:95], v[128:143]
v_exp_f32 v69, v69
v_add_f32 v7, v7, v68
ds_write_b128 v8, a[4:7] offset:1024
v_mfma_f32_32x32x16_bf16 a[48:63], a[244:247], v[92:95], a[48:63]
v_exp_f32 v70, v70
v_add_f32 v7, v7, v69
v_exp_f32 v71, v71
v_cvt_pk_bf16_f32 v106, v68, v69
ds_write_b128 v8, a[8:11] offset:2048
v_mfma_f32_32x32x16_bf16 a[64:79], a[248:251], v[92:95], a[64:79]
v_exp_f32 v72, v72
v_add_f32 v7, v7, v70
v_exp_f32 v73, v73
v_add_f32 v7, v7, v71
v_cvt_pk_bf16_f32 v107, v70, v71
ds_write_b128 v8, a[12:15] offset:3072
v_mfma_f32_32x32x16_bf16 a[80:95], a[252:255], v[92:95], a[80:95]
v_exp_f32 v74, v74
v_add_f32 v7, v7, v72
v_exp_f32 v75, v75
v_add_f32 v7, v7, v73
v_cvt_pk_bf16_f32 v108, v72, v73
ds_write_b128 v9, a[16:19] offset:0
v_mfma_f32_32x32x16_bf16 v[128:143], v[144:147], v[104:107], v[128:143]
v_exp_f32 v76, v76
v_add_f32 v7, v7, v74
v_exp_f32 v77, v77
v_add_f32 v7, v7, v75
v_cvt_pk_bf16_f32 v109, v74, v75
ds_write_b128 v9, a[20:23] offset:1024
v_mfma_f32_32x32x16_bf16 a[48:63], v[148:151], v[104:107], a[48:63]
v_exp_f32 v78, v78
v_add_f32 v7, v7, v76
v_exp_f32 v79, v79
v_add_f32 v7, v7, v77
v_cvt_pk_bf16_f32 v110, v76, v77
ds_write_b128 v9, a[24:27] offset:2048
v_mfma_f32_32x32x16_bf16 a[64:79], v[152:155], v[104:107], a[64:79]
v_add_f32 v7, v7, v78
v_add_f32 v7, v7, v79
v_cvt_pk_bf16_f32 v111, v78, v79
ds_write_b128 v9, a[28:31] offset:3072
v_mfma_f32_32x32x16_bf16 a[80:95], v[156:159], v[104:107], a[80:95]
ds_write_b128 v10, a[32:35] offset:0
v_mfma_f32_32x32x16_bf16 v[128:143], v[160:163], v[108:111], v[128:143]
ds_write_b128 v10, a[36:39] offset:1024
ds_write_b128 v10, a[40:43] offset:2048
ds_write_b128 v10, a[44:47] offset:3072
v_mfma_f32_32x32x16_bf16 a[48:63], v[164:167], v[108:111], a[48:63]
v_mfma_f32_32x32x16_bf16 a[64:79], v[168:171], v[108:111], a[64:79]
v_mfma_f32_32x32x16_bf16 a[80:95], v[172:175], v[108:111], a[80:95]
L_EPI:
s_waitcnt lgkmcnt(0)
s_barrier
ds_read_b128 v[64:67], v13 offset:0
ds_read_b128 v[68:71], v13 offset:16
ds_read_b128 v[16:19], v11 offset:0
ds_read_b128 v[20:23], v11 offset:1024
ds_read_b128 v[24:27], v11 offset:2048
ds_read_b128 v[28:31], v11 offset:3072
ds_read_b128 v[32:35], v11 offset:4096
ds_read_b128 v[36:39], v11 offset:5120
ds_read_b128 v[40:43], v11 offset:6144
ds_read_b128 v[44:47], v11 offset:7168
ds_read_b128 v[48:51], v11 offset:8192
ds_read_b128 v[52:55], v11 offset:9216
ds_read_b128 v[56:59], v11 offset:10240
ds_read_b128 v[60:63], v11 offset:11264
ds_write_b32 v12, v7 offset:1024
s_waitcnt lgkmcnt(1)
v_add_f32 v64, v64, v65
v_add_f32 v66, v66, v67
v_add_f32 v68, v68, v69
v_add_f32 v70, v70, v71
v_add_f32 v64, v64, v66
v_add_f32 v68, v68, v70
v_add_f32 v6, v64, v68
v_pk_add_f32 v[112:113], v[112:113], v[16:17]
v_pk_add_f32 v[114:115], v[114:115], v[18:19]
v_pk_add_f32 v[116:117], v[116:117], v[20:21]
v_pk_add_f32 v[118:119], v[118:119], v[22:23]
v_pk_add_f32 v[120:121], v[120:121], v[24:25]
v_pk_add_f32 v[122:123], v[122:123], v[26:27]
v_pk_add_f32 v[124:125], v[124:125], v[28:29]
v_pk_add_f32 v[126:127], v[126:127], v[30:31]
v_pk_add_f32 v[112:113], v[112:113], v[32:33]
v_pk_add_f32 v[114:115], v[114:115], v[34:35]
v_pk_add_f32 v[116:117], v[116:117], v[36:37]
v_pk_add_f32 v[118:119], v[118:119], v[38:39]
v_pk_add_f32 v[120:121], v[120:121], v[40:41]
v_pk_add_f32 v[122:123], v[122:123], v[42:43]
v_pk_add_f32 v[124:125], v[124:125], v[44:45]
v_pk_add_f32 v[126:127], v[126:127], v[46:47]
v_pk_add_f32 v[112:113], v[112:113], v[48:49]
v_pk_add_f32 v[114:115], v[114:115], v[50:51]
v_pk_add_f32 v[116:117], v[116:117], v[52:53]
v_pk_add_f32 v[118:119], v[118:119], v[54:55]
v_pk_add_f32 v[120:121], v[120:121], v[56:57]
v_pk_add_f32 v[122:123], v[122:123], v[58:59]
v_pk_add_f32 v[124:125], v[124:125], v[60:61]
v_pk_add_f32 v[126:127], v[126:127], v[62:63]
v_cvt_pk_bf16_f32 v72, v112, v113
v_cvt_pk_bf16_f32 v73, v114, v115
v_cvt_pk_bf16_f32 v74, v116, v117
v_cvt_pk_bf16_f32 v75, v118, v119
v_cvt_pk_bf16_f32 v76, v120, v121
v_cvt_pk_bf16_f32 v77, v122, v123
v_cvt_pk_bf16_f32 v78, v124, v125
v_cvt_pk_bf16_f32 v79, v126, v127
buffer_store_dwordx4 v[72:75], v1, s[12:15], s46 offen sc1
buffer_store_dwordx4 v[76:79], v1, s[12:15], s46 offen offset:1024 sc1
buffer_store_dword v6, v14, s[12:15], s47 offen sc1
ds_write_b128 v8, a[48:51] offset:49152
ds_write_b128 v8, a[52:55] offset:50176
ds_write_b128 v8, a[56:59] offset:51200
ds_write_b128 v8, a[60:63] offset:52224
ds_write_b128 v9, a[64:67] offset:49152
ds_write_b128 v9, a[68:71] offset:50176
ds_write_b128 v9, a[72:75] offset:51200
ds_write_b128 v9, a[76:79] offset:52224
ds_write_b128 v10, a[80:83] offset:49152
ds_write_b128 v10, a[84:87] offset:50176
ds_write_b128 v10, a[88:91] offset:51200
ds_write_b128 v10, a[92:95] offset:52224
buffer_load_dwordx4 v[80:83], v1, s[12:15], s44 offen sc1
buffer_load_dwordx4 v[84:87], v1, s[12:15], s44 offen offset:1024 sc1
buffer_load_dword v88, v14, s[12:15], s45 offen sc1
s_waitcnt lgkmcnt(0)
s_barrier
ds_read_b128 v[64:67], v13 offset:1024
ds_read_b128 v[68:71], v13 offset:1040
ds_read_b128 v[16:19], v11 offset:49152
ds_read_b128 v[20:23], v11 offset:50176
ds_read_b128 v[24:27], v11 offset:51200
ds_read_b128 v[28:31], v11 offset:52224
ds_read_b128 v[32:35], v11 offset:53248
ds_read_b128 v[36:39], v11 offset:54272
ds_read_b128 v[40:43], v11 offset:55296
ds_read_b128 v[44:47], v11 offset:56320
ds_read_b128 v[48:51], v11 offset:57344
ds_read_b128 v[52:55], v11 offset:58368
ds_read_b128 v[56:59], v11 offset:59392
ds_read_b128 v[60:63], v11 offset:60416
s_mov_b32 s10, 0
s_waitcnt lgkmcnt(0)
v_add_f32 v64, v64, v65
v_add_f32 v66, v66, v67
v_add_f32 v68, v68, v69
v_add_f32 v70, v70, v71
v_add_f32 v64, v64, v66
v_add_f32 v68, v68, v70
v_add_f32 v7, v64, v68
v_pk_add_f32 v[128:129], v[128:129], v[16:17]
v_pk_add_f32 v[130:131], v[130:131], v[18:19]
v_pk_add_f32 v[132:133], v[132:133], v[20:21]
v_pk_add_f32 v[134:135], v[134:135], v[22:23]
v_pk_add_f32 v[136:137], v[136:137], v[24:25]
v_pk_add_f32 v[138:139], v[138:139], v[26:27]
v_pk_add_f32 v[140:141], v[140:141], v[28:29]
v_pk_add_f32 v[142:143], v[142:143], v[30:31]
v_pk_add_f32 v[128:129], v[128:129], v[32:33]
v_pk_add_f32 v[130:131], v[130:131], v[34:35]
v_pk_add_f32 v[132:133], v[132:133], v[36:37]
v_pk_add_f32 v[134:135], v[134:135], v[38:39]
v_pk_add_f32 v[136:137], v[136:137], v[40:41]
v_pk_add_f32 v[138:139], v[138:139], v[42:43]
v_pk_add_f32 v[140:141], v[140:141], v[44:45]
v_pk_add_f32 v[142:143], v[142:143], v[46:47]
v_pk_add_f32 v[128:129], v[128:129], v[48:49]
v_pk_add_f32 v[130:131], v[130:131], v[50:51]
v_pk_add_f32 v[132:133], v[132:133], v[52:53]
v_pk_add_f32 v[134:135], v[134:135], v[54:55]
v_pk_add_f32 v[136:137], v[136:137], v[56:57]
v_pk_add_f32 v[138:139], v[138:139], v[58:59]
v_pk_add_f32 v[140:141], v[140:141], v[60:61]
v_pk_add_f32 v[142:143], v[142:143], v[62:63]
s_branch L_POLLW
L_POLL:
buffer_load_dwordx4 v[80:83], v1, s[12:15], s44 offen sc1
buffer_load_dwordx4 v[84:87], v1, s[12:15], s44 offen offset:1024 sc1
buffer_load_dword v88, v14, s[12:15], s45 offen sc1
L_POLLW:
s_waitcnt vmcnt(0)
L_POLLT:
v_max3_u32 v90, v80, v81, v82
v_max3_u32 v91, v83, v84, v85
v_max3_u32 v92, v86, v87, v88
v_max3_u32 v90, v90, v91, v92
v_cmp_eq_u32 vcc, -1, v90
s_add_u32 s10, s10, 1
s_cmp_ge_u32 s10, 200
s_cbranch_scc1 L_FALLBACK
s_cbranch_vccnz L_POLL
L_GOT:
v_add_f32 v7, v7, v88
v_lshlrev_b32 v16, 16, v80
v_and_b32 v17, 0xffff0000, v80
v_lshlrev_b32 v18, 16, v81
v_and_b32 v19, 0xffff0000, v81
v_lshlrev_b32 v20, 16, v82
v_and_b32 v21, 0xffff0000, v82
v_lshlrev_b32 v22, 16, v83
v_and_b32 v23, 0xffff0000, v83
v_lshlrev_b32 v24, 16, v84
v_and_b32 v25, 0xffff0000, v84
v_lshlrev_b32 v26, 16, v85
v_and_b32 v27, 0xffff0000, v85
v_lshlrev_b32 v28, 16, v86
v_and_b32 v29, 0xffff0000, v86
v_lshlrev_b32 v30, 16, v87
v_and_b32 v31, 0xffff0000, v87
v_rcp_f32 v32, v7
v_pk_add_f32 v[128:129], v[128:129], v[16:17]
v_pk_add_f32 v[130:131], v[130:131], v[18:19]
v_pk_add_f32 v[132:133], v[132:133], v[20:21]
v_pk_add_f32 v[134:135], v[134:135], v[22:23]
v_pk_add_f32 v[136:137], v[136:137], v[24:25]
v_pk_add_f32 v[138:139], v[138:139], v[26:27]
v_pk_add_f32 v[140:141], v[140:141], v[28:29]
v_pk_add_f32 v[142:143], v[142:143], v[30:31]
v_pk_mul_f32 v[34:35], v[128:129], 0
v_pk_fma_f32 v[34:35], v[130:131], 0, v[34:35]
v_pk_fma_f32 v[34:35], v[132:133], 0, v[34:35]
v_pk_fma_f32 v[34:35], v[134:135], 0, v[34:35]
v_pk_fma_f32 v[34:35], v[136:137], 0, v[34:35]
v_pk_fma_f32 v[34:35], v[138:139], 0, v[34:35]
v_pk_fma_f32 v[34:35], v[140:141], 0, v[34:35]
v_pk_fma_f32 v[34:35], v[142:143], 0, v[34:35]
s_mov_b32 s9, 0x30800000
s_mov_b32 s10, 0x4e800000
v_cmp_le_f32 s[46:47], s9, v7
v_cmp_ge_f32 s[8:9], s10, v7
v_cmp_o_f32 vcc, v34, v35
v_mov_b32 v33, v32
s_and_b64 s[46:47], s[46:47], s[8:9]
s_and_b64 s[46:47], s[46:47], vcc
s_cmp_eq_u64 s[46:47], exec
s_cbranch_scc0 L_FALLBACK
v_pk_mul_f32 v[128:129], v[128:129], v[32:33]
v_pk_mul_f32 v[130:131], v[130:131], v[32:33]
v_pk_mul_f32 v[132:133], v[132:133], v[32:33]
v_pk_mul_f32 v[134:135], v[134:135], v[32:33]
v_pk_mul_f32 v[136:137], v[136:137], v[32:33]
v_pk_mul_f32 v[138:139], v[138:139], v[32:33]
v_pk_mul_f32 v[140:141], v[140:141], v[32:33]
v_pk_mul_f32 v[142:143], v[142:143], v[32:33]
L_STORE:
v_cvt_pk_bf16_f32 v72, v128, v129
v_cvt_pk_bf16_f32 v73, v130, v131
v_cvt_pk_bf16_f32 v74, v132, v133
v_cvt_pk_bf16_f32 v75, v134, v135
v_cvt_pk_bf16_f32 v76, v136, v137
v_cvt_pk_bf16_f32 v77, v138, v139
v_cvt_pk_bf16_f32 v78, v140, v141
v_cvt_pk_bf16_f32 v79, v142, v143
v_lshrrev_b32 v37, 5, v0
v_lshl_add_u32 v36, v37, 5, v15
buffer_store_dwordx4 v[72:75], v36, s[16:19], s42 offen nt
buffer_store_dwordx4 v[76:79], v36, s[16:19], s42 offen offset:16 nt
L_END:
s_endpgm
L_WAVEFAIL:
s_mov_b64 exec, -1
s_waitcnt vmcnt(0) lgkmcnt(0)
v_lshlrev_b32 v19, 2, v0
v_mov_b32 v136, -1
v_mov_b32 v137, -1
v_mov_b32 v138, -1
v_mov_b32 v139, -1
buffer_store_dwordx4 v[136:139], v1, s[12:15], s44 offen sc1
buffer_store_dwordx4 v[136:139], v1, s[12:15], s44 offen offset:1024 sc1
buffer_store_dword v136, v19, s[12:15], s45 offen sc1
s_add_u32 s9, s3, 1
s_and_b32 s9, s9, 3
s_mul_i32 s9, s9, 12288
s_add_u32 s9, s9, 16384
v_add_u32 v8, s9, v1
s_add_u32 s9, s3, 2
s_and_b32 s9, s9, 3
s_mul_i32 s9, s9, 12288
s_add_u32 s9, s9, 20480
v_add_u32 v9, s9, v1
s_add_u32 s9, s3, 3
s_and_b32 s9, s9, 3
s_mul_i32 s9, s9, 12288
s_add_u32 s9, s9, 24576
v_add_u32 v10, s9, v1
s_mul_i32 s9, s3, 12288
s_add_u32 s9, s9, 16384
v_add_u32 v11, s9, v1
v_and_b32 v15, 31, v0
v_lshlrev_b32 v13, 5, v15
v_add_u32 v13, 114688, v13
v_lshrrev_b32 v15, 5, v0
v_lshl_add_u32 v12, v15, 2, v13
s_lshl_b32 s9, s3, 3
v_add_u32 v12, s9, v12
v_lshlrev_b32 v14, 2, v0
s_xor_b32 s46, s44, 8192
s_xor_b32 s47, s45, 1024
s_lshl_b32 s9, s4, 6
s_lshl_b32 s10, s6, 1
s_add_u32 s9, s9, s10
s_add_u32 s9, s9, s5
s_lshl_b32 s9, s9, 13
s_lshl_b32 s10, s3, 6
s_add_u32 s42, s9, s10
v_and_b32 v15, 31, v0
v_lshlrev_b32 v15, 8, v15
s_mov_b32 s16, s40
s_and_b32 s17, s41, 0xffff
s_mov_b32 s18, 2097152
s_mov_b32 s19, 0x20000
v_mov_b32 v6, 0x7fc00000
v_mov_b32 v7, 0x7fc00000
ds_write_b32 v12, v6 offset:0
s_waitcnt vmcnt(0)
s_branch L_EPI
L_FALLBACK:
s_waitcnt vmcnt(0) lgkmcnt(0)
s_load_dwordx16 s[20:35], s[0:1], 0
v_and_b32 v145, 31, v0
v_lshrrev_b32 v146, 5, v0
v_lshlrev_b32 v148, 9, v145
v_lshl_add_u32 v148, v146, 4, v148
v_lshlrev_b32 v149, 3, v145
v_bfe_u32 v110, v145, 2, 1
v_lshlrev_b32 v110, 4, v110
v_lshrrev_b32 v111, 3, v145
v_lshl_add_u32 v110, v111, 2, v110
v_and_b32 v111, 3, v145
v_add_u32 v110, v110, v111
s_lshl_b32 s9, s3, 5
v_add_u32 v110, s9, v110
v_lshlrev_b32 v110, 2, v110
v_lshl_add_u32 v150, v146, 11, v110
s_lshl_b32 s9, s3, 1
v_lshlrev_b32 v151, 5, v146
v_add_u32 v151, s9, v151
v_mov_b32 v108, 0xff800000
v_mov_b32 v109, 0
v_mov_b32 v128, 0
v_mov_b32 v129, 0
v_mov_b32 v130, 0
v_mov_b32 v131, 0
v_mov_b32 v132, 0
v_mov_b32 v133, 0
v_mov_b32 v134, 0
v_mov_b32 v135, 0
v_mov_b32 v136, 0
v_mov_b32 v137, 0
v_mov_b32 v138, 0
v_mov_b32 v139, 0
v_mov_b32 v140, 0
v_mov_b32 v141, 0
v_mov_b32 v142, 0
v_mov_b32 v143, 0
s_waitcnt lgkmcnt(0)
s_lshl_b32 s8, s4, 20
s_lshl_b32 s9, s4, 14
s_add_u32 s22, s22, s8
s_addc_u32 s23, s23, 0
s_add_u32 s28, s28, s8
s_addc_u32 s29, s29, 0
s_add_u32 s24, s24, s9
s_addc_u32 s25, s25, 0
s_add_u32 s26, s26, s9
s_addc_u32 s27, s27, 0
s_add_u32 s30, s30, s9
s_addc_u32 s31, s31, 0
s_add_u32 s32, s32, s9
s_addc_u32 s33, s33, 0
s_mov_b32 s48, 0
L_FB_TILE:
global_load_dwordx2 v[48:49], v149, s[24:25]
global_load_dwordx2 v[50:51], v149, s[26:27]
s_lshl_b32 s49, s48, 5
v_add_u32 v144, s49, v145
v_cvt_f32_u32 v144, v144
v_mov_b32 v16, 0
v_mov_b32 v17, 0
v_mov_b32 v18, 0
v_mov_b32 v19, 0
v_mov_b32 v20, 0
v_mov_b32 v21, 0
v_mov_b32 v22, 0
v_mov_b32 v23, 0
v_mov_b32 v24, 0
v_mov_b32 v25, 0
v_mov_b32 v26, 0
v_mov_b32 v27, 0
v_mov_b32 v28, 0
v_mov_b32 v29, 0
v_mov_b32 v30, 0
v_mov_b32 v31, 0
s_mov_b32 s50, 0
L_FB_KS:
s_lshl_b32 s51, s50, 5
v_add_u32 v147, s51, v148
global_load_dwordx4 v[40:43], v147, s[22:23]
global_load_dwordx4 v[44:47], v147, s[22:23] offset:256
s_and_b32 s51, s50, 3
s_lshl_b32 s51, s51, 1
v_add_u32 v147, s51, v146
v_xor_b32 v147, v147, v0
v_lshlrev_b32 v147, 4, v147
s_lshl_b32 s51, s50, 10
s_add_u32 s51, s51, 8192
v_add_u32 v147, s51, v147
ds_read_b128 v[72:75], v147
s_lshl_b32 s51, s50, 1
v_add_u32 v110, s51, v146
v_lshlrev_b32 v110, 2, v110
v_cvt_f32_u32 v110, v110
s_mov_b32 s51, 0xbe549a78
v_mov_b32 v76, 0xc029b21d
v_mov_b32 v77, 0xc036fbc4
v_mov_b32 v78, 0xc044456c
v_mov_b32 v79, 0xc0518f13
v_fma_f32 v76, v110, s51, v76
v_fma_f32 v77, v110, s51, v77
v_fma_f32 v78, v110, s51, v78
v_fma_f32 v79, v110, s51, v79
v_exp_f32 v76, v76
v_exp_f32 v77, v77
v_exp_f32 v78, v78
v_exp_f32 v79, v79
s_nop 0
v_mul_f32 v76, v144, v76
v_mul_f32 v77, v144, v77
v_mul_f32 v78, v144, v78
v_mul_f32 v79, v144, v79
v_fract_f32 v76, v76
v_fract_f32 v77, v77
v_fract_f32 v78, v78
v_fract_f32 v79, v79
v_cos_f32 v52, v76
v_sin_f32 v56, v76
v_cos_f32 v53, v77
v_sin_f32 v57, v77
v_cos_f32 v54, v78
v_sin_f32 v58, v78
v_cos_f32 v55, v79
v_sin_f32 v59, v79
s_cmp_lt_u32 s50, 4
s_cselect_b32 s51, 16, 0
s_waitcnt vmcnt(0) lgkmcnt(0)
v_lshlrev_b32 v60, s51, v48
v_lshlrev_b32 v61, s51, v49
v_lshlrev_b32 v62, s51, v50
v_lshlrev_b32 v63, s51, v51
v_and_b32 v76, 0xffff0000, v60
v_and_b32 v77, 0xffff0000, v61
v_and_b32 v78, 0xffff0000, v62
v_and_b32 v79, 0xffff0000, v63
v_cvt_f32_i32 v40, v40
v_cvt_f32_i32 v41, v41
v_cvt_f32_i32 v42, v42
v_cvt_f32_i32 v43, v43
v_cvt_f32_i32 v44, v44
v_cvt_f32_i32 v45, v45
v_cvt_f32_i32 v46, v46
v_cvt_f32_i32 v47, v47
v_sub_f32 v40, v40, v78
v_sub_f32 v41, v41, v78
v_sub_f32 v42, v42, v78
v_sub_f32 v43, v43, v78
v_sub_f32 v44, v44, v79
v_sub_f32 v45, v45, v79
v_sub_f32 v46, v46, v79
v_sub_f32 v47, v47, v79
v_mul_f32 v40, v40, v76
v_mul_f32 v41, v41, v76
v_mul_f32 v42, v42, v76
v_mul_f32 v43, v43, v76
v_mul_f32 v44, v44, v77
v_mul_f32 v45, v45, v77
v_mul_f32 v46, v46, v77
v_mul_f32 v47, v47, v77
v_mul_f32 v60, v44, v56
v_mul_f32 v64, v40, v56
v_mul_f32 v61, v45, v57
v_mul_f32 v65, v41, v57
v_mul_f32 v62, v46, v58
v_mul_f32 v66, v42, v58
v_mul_f32 v63, v47, v59
v_mul_f32 v67, v43, v59
v_fma_f32 v60, v40, v52, -v60
v_fma_f32 v64, v44, v52, v64
v_fma_f32 v61, v41, v53, -v61
v_fma_f32 v65, v45, v53, v65
v_fma_f32 v62, v42, v54, -v62
v_fma_f32 v66, v46, v54, v66
v_fma_f32 v63, v43, v55, -v63
v_fma_f32 v67, v47, v55, v67
v_cvt_pk_bf16_f32 v68, v60, v61
v_cvt_pk_bf16_f32 v69, v62, v63
v_cvt_pk_bf16_f32 v70, v64, v65
v_cvt_pk_bf16_f32 v71, v66, v67
s_nop 1
v_mfma_f32_32x32x16_bf16 v[16:31], v[68:71], v[72:75], v[16:31]
s_nop 15
s_add_u32 s50, s50, 1
s_cmp_lt_u32 s50, 8
s_cbranch_scc1 L_FB_KS
v_max3_f32 v110, v16, v17, v18
v_max3_f32 v110, v110, v19, v20
v_max3_f32 v110, v110, v21, v22
v_max3_f32 v110, v110, v23, v24
v_max3_f32 v110, v110, v25, v26
v_max3_f32 v110, v110, v27, v28
v_max3_f32 v110, v110, v29, v30
v_max_f32 v110, v110, v31
v_mov_b32 v111, v110
s_nop 1
v_permlane32_swap_b32 v110, v111
s_nop 1
v_max3_f32 v110, v110, v111, v108
v_sub_f32 v111, v108, v110
v_exp_f32 v111, v111
v_mov_b32 v108, v110
v_sub_f32 v16, v16, v110
v_sub_f32 v17, v17, v110
v_sub_f32 v18, v18, v110
v_sub_f32 v19, v19, v110
v_sub_f32 v20, v20, v110
v_sub_f32 v21, v21, v110
v_sub_f32 v22, v22, v110
v_sub_f32 v23, v23, v110
v_sub_f32 v24, v24, v110
v_sub_f32 v25, v25, v110
v_sub_f32 v26, v26, v110
v_sub_f32 v27, v27, v110
v_sub_f32 v28, v28, v110
v_sub_f32 v29, v29, v110
v_sub_f32 v30, v30, v110
v_sub_f32 v31, v31, v110
v_exp_f32 v16, v16
v_exp_f32 v17, v17
v_exp_f32 v18, v18
v_exp_f32 v19, v19
v_exp_f32 v20, v20
v_exp_f32 v21, v21
v_exp_f32 v22, v22
v_exp_f32 v23, v23
v_exp_f32 v24, v24
v_exp_f32 v25, v25
v_exp_f32 v26, v26
v_exp_f32 v27, v27
v_exp_f32 v28, v28
v_exp_f32 v29, v29
v_exp_f32 v30, v30
v_exp_f32 v31, v31
v_mul_f32 v109, v109, v111
v_mul_f32 v128, v128, v111
v_mul_f32 v129, v129, v111
v_mul_f32 v130, v130, v111
v_mul_f32 v131, v131, v111
v_mul_f32 v132, v132, v111
v_mul_f32 v133, v133, v111
v_mul_f32 v134, v134, v111
v_mul_f32 v135, v135, v111
v_mul_f32 v136, v136, v111
v_mul_f32 v137, v137, v111
v_mul_f32 v138, v138, v111
v_mul_f32 v139, v139, v111
v_mul_f32 v140, v140, v111
v_mul_f32 v141, v141, v111
v_mul_f32 v142, v142, v111
v_mul_f32 v143, v143, v111
v_add_f32 v109, v109, v16
v_add_f32 v109, v109, v17
v_add_f32 v109, v109, v18
v_add_f32 v109, v109, v19
v_add_f32 v109, v109, v20
v_add_f32 v109, v109, v21
v_add_f32 v109, v109, v22
v_add_f32 v109, v109, v23
v_add_f32 v109, v109, v24
v_add_f32 v109, v109, v25
v_add_f32 v109, v109, v26
v_add_f32 v109, v109, v27
v_add_f32 v109, v109, v28
v_add_f32 v109, v109, v29
v_add_f32 v109, v109, v30
v_add_f32 v109, v109, v31
v_cvt_pk_bf16_f32 v32, v16, v17
v_cvt_pk_bf16_f32 v33, v18, v19
v_cvt_pk_bf16_f32 v34, v20, v21
v_cvt_pk_bf16_f32 v35, v22, v23
v_cvt_pk_bf16_f32 v36, v24, v25
v_cvt_pk_bf16_f32 v37, v26, v27
v_cvt_pk_bf16_f32 v38, v28, v29
v_cvt_pk_bf16_f32 v39, v30, v31
v_add_u32 v147, 0, v150
v_add_u32 v110, 4096, v150
global_load_dword v80, v147, s[28:29] offset:0
global_load_dword v81, v147, s[28:29] offset:512
global_load_dword v82, v147, s[28:29] offset:1024
global_load_dword v83, v147, s[28:29] offset:1536
global_load_dword v84, v110, s[28:29] offset:0
global_load_dword v85, v110, s[28:29] offset:512
global_load_dword v86, v110, s[28:29] offset:1024
global_load_dword v87, v110, s[28:29] offset:1536
global_load_ushort v88, v151, s[30:31] offset:0
global_load_ushort v96, v151, s[32:33] offset:0
global_load_ushort v89, v151, s[30:31] offset:8
global_load_ushort v97, v151, s[32:33] offset:8
global_load_ushort v90, v151, s[30:31] offset:16
global_load_ushort v98, v151, s[32:33] offset:16
global_load_ushort v91, v151, s[30:31] offset:24
global_load_ushort v99, v151, s[32:33] offset:24
global_load_ushort v92, v151, s[30:31] offset:64
global_load_ushort v100, v151, s[32:33] offset:64
global_load_ushort v93, v151, s[30:31] offset:72
global_load_ushort v101, v151, s[32:33] offset:72
global_load_ushort v94, v151, s[30:31] offset:80
global_load_ushort v102, v151, s[32:33] offset:80
global_load_ushort v95, v151, s[30:31] offset:88
global_load_ushort v103, v151, s[32:33] offset:88
s_waitcnt vmcnt(0)
v_cvt_f32_i32 v80, v80
v_lshlrev_b32 v88, 16, v88
v_lshlrev_b32 v96, 16, v96
v_cvt_f32_i32 v81, v81
v_lshlrev_b32 v89, 16, v89
v_lshlrev_b32 v97, 16, v97
v_cvt_f32_i32 v82, v82
v_lshlrev_b32 v90, 16, v90
v_lshlrev_b32 v98, 16, v98
v_cvt_f32_i32 v83, v83
v_lshlrev_b32 v91, 16, v91
v_lshlrev_b32 v99, 16, v99
v_cvt_f32_i32 v84, v84
v_lshlrev_b32 v92, 16, v92
v_lshlrev_b32 v100, 16, v100
v_cvt_f32_i32 v85, v85
v_lshlrev_b32 v93, 16, v93
v_lshlrev_b32 v101, 16, v101
v_cvt_f32_i32 v86, v86
v_lshlrev_b32 v94, 16, v94
v_lshlrev_b32 v102, 16, v102
v_cvt_f32_i32 v87, v87
v_lshlrev_b32 v95, 16, v95
v_lshlrev_b32 v103, 16, v103
v_sub_f32 v80, v80, v96
v_sub_f32 v81, v81, v97
v_sub_f32 v82, v82, v98
v_sub_f32 v83, v83, v99
v_sub_f32 v84, v84, v100
v_sub_f32 v85, v85, v101
v_sub_f32 v86, v86, v102
v_sub_f32 v87, v87, v103
v_mul_f32 v80, v80, v88
v_mul_f32 v81, v81, v89
v_mul_f32 v82, v82, v90
v_mul_f32 v83, v83, v91
v_mul_f32 v84, v84, v92
v_mul_f32 v85, v85, v93
v_mul_f32 v86, v86, v94
v_mul_f32 v87, v87, v95
v_cvt_pk_bf16_f32 v104, v80, v81
v_cvt_pk_bf16_f32 v105, v82, v83
v_cvt_pk_bf16_f32 v106, v84, v85
v_cvt_pk_bf16_f32 v107, v86, v87
s_nop 1
v_mfma_f32_32x32x16_bf16 v[128:143], v[104:107], v[32:35], v[128:143]
s_nop 15
v_add_u32 v147, 8192, v150
v_add_u32 v110, 12288, v150
global_load_dword v80, v147, s[28:29] offset:0
global_load_dword v81, v147, s[28:29] offset:512
global_load_dword v82, v147, s[28:29] offset:1024
global_load_dword v83, v147, s[28:29] offset:1536
global_load_dword v84, v110, s[28:29] offset:0
global_load_dword v85, v110, s[28:29] offset:512
global_load_dword v86, v110, s[28:29] offset:1024
global_load_dword v87, v110, s[28:29] offset:1536
global_load_ushort v88, v151, s[30:31] offset:128
global_load_ushort v96, v151, s[32:33] offset:128
global_load_ushort v89, v151, s[30:31] offset:136
global_load_ushort v97, v151, s[32:33] offset:136
global_load_ushort v90, v151, s[30:31] offset:144
global_load_ushort v98, v151, s[32:33] offset:144
global_load_ushort v91, v151, s[30:31] offset:152
global_load_ushort v99, v151, s[32:33] offset:152
global_load_ushort v92, v151, s[30:31] offset:192
global_load_ushort v100, v151, s[32:33] offset:192
global_load_ushort v93, v151, s[30:31] offset:200
global_load_ushort v101, v151, s[32:33] offset:200
global_load_ushort v94, v151, s[30:31] offset:208
global_load_ushort v102, v151, s[32:33] offset:208
global_load_ushort v95, v151, s[30:31] offset:216
global_load_ushort v103, v151, s[32:33] offset:216
s_waitcnt vmcnt(0)
v_cvt_f32_i32 v80, v80
v_lshlrev_b32 v88, 16, v88
v_lshlrev_b32 v96, 16, v96
v_cvt_f32_i32 v81, v81
v_lshlrev_b32 v89, 16, v89
v_lshlrev_b32 v97, 16, v97
v_cvt_f32_i32 v82, v82
v_lshlrev_b32 v90, 16, v90
v_lshlrev_b32 v98, 16, v98
v_cvt_f32_i32 v83, v83
v_lshlrev_b32 v91, 16, v91
v_lshlrev_b32 v99, 16, v99
v_cvt_f32_i32 v84, v84
v_lshlrev_b32 v92, 16, v92
v_lshlrev_b32 v100, 16, v100
v_cvt_f32_i32 v85, v85
v_lshlrev_b32 v93, 16, v93
v_lshlrev_b32 v101, 16, v101
v_cvt_f32_i32 v86, v86
v_lshlrev_b32 v94, 16, v94
v_lshlrev_b32 v102, 16, v102
v_cvt_f32_i32 v87, v87
v_lshlrev_b32 v95, 16, v95
v_lshlrev_b32 v103, 16, v103
v_sub_f32 v80, v80, v96
v_sub_f32 v81, v81, v97
v_sub_f32 v82, v82, v98
v_sub_f32 v83, v83, v99
v_sub_f32 v84, v84, v100
v_sub_f32 v85, v85, v101
v_sub_f32 v86, v86, v102
v_sub_f32 v87, v87, v103
v_mul_f32 v80, v80, v88
v_mul_f32 v81, v81, v89
v_mul_f32 v82, v82, v90
v_mul_f32 v83, v83, v91
v_mul_f32 v84, v84, v92
v_mul_f32 v85, v85, v93
v_mul_f32 v86, v86, v94
v_mul_f32 v87, v87, v95
v_cvt_pk_bf16_f32 v104, v80, v81
v_cvt_pk_bf16_f32 v105, v82, v83
v_cvt_pk_bf16_f32 v106, v84, v85
v_cvt_pk_bf16_f32 v107, v86, v87
s_nop 1
v_mfma_f32_32x32x16_bf16 v[128:143], v[104:107], v[36:39], v[128:143]
s_nop 15
s_add_u32 s22, s22, 16384
s_addc_u32 s23, s23, 0
s_add_u32 s28, s28, 16384
s_addc_u32 s29, s29, 0
s_add_u32 s24, s24, 256
s_addc_u32 s25, s25, 0
s_add_u32 s26, s26, 256
s_addc_u32 s27, s27, 0
s_add_u32 s30, s30, 256
s_addc_u32 s31, s31, 0
s_add_u32 s32, s32, 256
s_addc_u32 s33, s33, 0
s_add_u32 s48, s48, 1
s_cmp_lt_u32 s48, 64
s_cbranch_scc1 L_FB_TILE
v_mov_b32 v111, v109
s_nop 1
v_permlane32_swap_b32 v109, v111
s_nop 1
v_add_f32 v109, v109, v111
v_rcp_f32 v109, v109
s_nop 0
v_mul_f32 v128, v128, v109
v_mul_f32 v129, v129, v109
v_mul_f32 v130, v130, v109
v_mul_f32 v131, v131, v109
v_mul_f32 v132, v132, v109
v_mul_f32 v133, v133, v109
v_mul_f32 v134, v134, v109
v_mul_f32 v135, v135, v109
v_mul_f32 v136, v136, v109
v_mul_f32 v137, v137, v109
v_mul_f32 v138, v138, v109
v_mul_f32 v139, v139, v109
v_mul_f32 v140, v140, v109
v_mul_f32 v141, v141, v109
v_mul_f32 v142, v142, v109
v_mul_f32 v143, v143, v109
s_branch L_STORE
L_CODE_END:
s_endpgm
.section .rodata,"a"
.p2align 6
.amdhsa_kernel standalone__kv_cache_quant_pre_rope_vs_post_rope__prompt_kernel
  .amdhsa_next_free_vgpr 448
  .amdhsa_next_free_sgpr 100
  .amdhsa_accum_offset 192
  .amdhsa_group_segment_fixed_size 0
  .amdhsa_kernarg_size 112
  .amdhsa_user_sgpr_count 2
  .amdhsa_user_sgpr_kernarg_segment_ptr 1
  .amdhsa_system_sgpr_workgroup_id_x 1
.end_amdhsa_kernel
```
